```python
import torch

def _softmax(x, axis=-1):
    return torch.softmax(x, dim=axis)
def _gelu(x):
    return torch.nn.functional.gelu(x, approximate="tanh")
def _silu(x):
    return torch.nn.functional.silu(x)
def _sigmoid(x):
    return torch.sigmoid(x)
def _layernorm(x, axis=-1, eps=1e-5):
    m = x.mean(dim=axis, keepdim=True)
    v = x.var(dim=axis, keepdim=True, unbiased=False)
    return (x - m) / torch.sqrt(v + eps)
def _scatter_add(tgt, idx, src, axis=0):
    return tgt.clone().index_add_(axis, idx, src)
def _segment_sum(src, seg, n):
    out = torch.zeros((n,) + src.shape[1:], dtype=src.dtype)
    return out.index_add_(0, seg, src)
def _pad(x, pw):
    flat = tuple(v for pair in reversed(pw) for v in pair)
    return torch.nn.functional.pad(x, flat)

kernel_name = 'gated_mix__spectral_gfnet__dense_activation_mish__prompt'

def setup_inputs():

    _w = (lambda a: (lambda t: t.to(torch.bfloat16) if t.is_floating_point() else t)(torch.as_tensor(a)))
    def _A_setup():
        B, S, D = 1, 2048, 512
        Df = D // 2 + 1
        return {
            "x": _w((lambda *s: torch.randn(*s, dtype=torch.bfloat16) * 0.05)(B, S, D)),
            "w_r": _w((lambda *s: torch.randn(*s, dtype=torch.bfloat16) * 0.8)(S, Df) * 0.02),
            "w_i": _w((lambda *s: torch.randn(*s, dtype=torch.bfloat16) * 0.8)(S, Df) * 0.02),
        }
    _A_in = _A_setup()

    def _B_setup():
        B, S, D, F = 1, 2048, 512, 1376
        return {
            "x": _w((lambda *s: torch.randn(*s, dtype=torch.bfloat16) * 0.05)(B, S, D)),
            "w1": _w((lambda *s: torch.randn(*s, dtype=torch.bfloat16) * 3.2)(D, F) * (D ** -0.5)),
            "b1": _w((lambda *s: torch.randn(*s, dtype=torch.bfloat16) * 0.05)(F)),
            "w2": _w((lambda *s: torch.randn(*s, dtype=torch.bfloat16) * 0.05)(F, D) * (F ** -0.5)),
        }
    _B_in = _B_setup()

    return {
        "A_x": _A_in["x"],
        "A_w_r": _A_in["w_r"],
        "A_w_i": _A_in["w_i"],
        "B_x": _B_in["x"],
        "B_w1": _B_in["w1"],
        "B_b1": _B_in["b1"],
        "B_w2": _B_in["w2"],
        "gate_w": _w((lambda *s: torch.randn(*s, dtype=torch.bfloat16) * 0.05)(512) * 16.0),
    }

def reference(A_x, A_w_r, A_w_i, B_x, B_w1, B_b1, B_w2, gate_w):
    def _A_ref(x, w_r, w_i):
        B, S, D = x.shape
        X = (lambda x, axes=(-2,-1): torch.fft.rfft2(x.float(), dim=axes))(x, axes=(-2, -1))
        W = w_r + 1j * w_i
        X = X * W
        y = (lambda x, s, axes=(-2,-1): torch.fft.irfft2(x, s=s, dim=axes).to(torch.bfloat16))(X, (S, D), axes=(-2, -1))
        return y

    def _B_ref(x, w1, b1, w2):
        h = torch.einsum("bsd,df->bsf", x, w1) + b1
        sp = torch.log1p(torch.exp(-torch.abs(h))) + torch.where(h > 0, h, torch.zeros_like(h))
        act = h * torch.tanh(sp)
        return torch.einsum("bsf,fd->bsd", act, w2)

    x = A_x
    g = _sigmoid((x * gate_w).sum(-1, keepdims=True))
    a = _A_ref(x, A_w_r, A_w_i)
    b = _B_ref(x, B_w1, B_b1, B_w2)
    return g * a + (1 - g) * b
```

```asm
; @launch grid=(256,1,1) block=(512,1,1) lds=163840
.amdgcn_target "amdgcn-amd-amdhsa--gfx950"
.text
.globl gated_mix__spectral_gfnet__dense_activation_mish__prompt_kernel
.p2align 8
.type gated_mix__spectral_gfnet__dense_activation_mish__prompt_kernel,@function
gated_mix__spectral_gfnet__dense_activation_mish__prompt_kernel:
L_start:
    s_cmp_ge_u32 s2, 256
    s_cbranch_scc1 L_end
    s_load_dwordx2 s[28:29], s[0:1], 0
    s_load_dwordx2 s[32:33], s[0:1], 8
    s_load_dwordx2 s[36:37], s[0:1], 16
    s_load_dwordx2 s[60:61], s[0:1], 80
    s_load_dwordx2 s[44:45], s[0:1], 40
    s_load_dwordx2 s[52:53], s[0:1], 56
    s_load_dwordx2 s[40:41], s[0:1], 32
    s_load_dwordx2 s[48:49], s[0:1], 48
    s_load_dwordx2 s[56:57], s[0:1], 64
    v_lshrrev_b32 v3, 6, v0
    v_and_b32 v1, 63, v0
    v_readfirstlane_b32 s4, v3
    v_and_b32 v0, 255, v0
    v_lshlrev_b32 v2, 4, v1
    s_getpc_b64 s[16:17]
L_pc:
    s_and_b32 s18, s2, 0xf8
    v_add_lshl_u32 v3, v3, s18, 7
    s_sub_u32 s16, s16, L_pc-L_start
    s_subb_u32 s17, s17, 0
    v_min_u32 v3, CODE_END-L_start-4, v3
    global_load_dword v175, v3, s[16:17]
    s_bfe_u32 s14, s2, 0x20001
    s_lshr_b32 s15, s2, 6
    s_lshl2_add_u32 s5, s14, s15
    s_and_b32 s14, s2, 1
    s_bfe_u32 s15, s2, 0x30003
    s_lshl3_add_u32 s6, s14, s15
    s_bfe_u32 s15, s2, 0x10005
    s_lshl1_add_u32 s9, s5, s15
    s_bfe_u32 s15, s2, 0x20003
    s_lshl2_add_u32 s10, s14, s15
    s_lshr_b32 s15, s9, 2
    s_lshl3_add_u32 s15, s15, s10
    s_and_b32 s16, s9, 3
    s_lshl2_add_u32 s8, s15, s16
    s_cmp_lt_u32 s4, 4
    s_cbranch_scc1 L_roleA
    s_and_b32 s4, s4, 3
    s_mov_b32 s34, 1052672
    s_mov_b32 s35, 0x20000
    s_mov_b32 s38, 1052672
    s_mov_b32 s39, 0x20000
    v_and_b32 v19, 1, v0
    v_mul_u32_u24 v19, 514, v19
    v_lshlrev_b32 v18, 1, v0
    v_and_b32 v18, 0x1fc, v18
    v_add_u32 v16, v19, v18
    s_lshr_b32 s18, s8, 6
    s_and_b32 s19, s8, 7
    s_lshl3_add_u32 s18, s18, s19
    s_bfe_u32 s19, s8, 0x20003
    s_bfe_u32 s20, s8, 0x10005
    s_lshl1_add_u32 s19, s19, s20
    s_lshl_b32 s19, s19, 8
    s_lshl1_add_u32 s18, s18, s19
    s_mul_i32 s18, s18, 514
    s_add_u32 s19, s18, 32896
    s_add_u32 s20, s18, 65792
    s_add_u32 s21, s18, 98688
    s_movk_i32 s22, 514
    s_waitcnt lgkmcnt(0)
    buffer_load_dword v32, v16, s[32:35], s18 offen
    buffer_load_dword v36, v16, s[36:39], s18 offen
    buffer_load_dword v33, v16, s[32:35], s19 offen
    buffer_load_dword v37, v16, s[36:39], s19 offen
    buffer_load_dword v34, v16, s[32:35], s20 offen
    buffer_load_dword v38, v16, s[36:39], s20 offen
    buffer_load_dword v35, v16, s[32:35], s21 offen
    buffer_load_dword v39, v16, s[36:39], s21 offen
    v_and_b32 v17, 3, v0
    v_mul_u32_u24 v17, 32896, v17
    v_bfe_u32 v18, v0, 2, 1
    v_mad_u32_u24 v17, v18, s22, v17
    v_cmp_gt_u32 vcc, 8, v0
    v_mov_b32 v18, 0x40000000
    s_nop 0
    v_cndmask_b32 v17, v18, v17, vcc
    buffer_load_ushort v48, v17, s[32:35], s18 offen offset:512
    buffer_load_ushort v49, v17, s[36:39], s18 offen offset:512
    s_mov_b32 s30, 2097152
    s_mov_b32 s31, 0x20000
    s_mov_b32 s42, 1409024
    s_mov_b32 s43, 0x20000
    s_and_b32 s14, s6, 7
    s_lshr_b32 s15, s6, 3
    s_add_u32 s79, s15, 5
    s_mul_i32 s15, s15, 21
    s_lshl1_add_u32 s7, s14, s79
    s_cmp_ge_u32 s14, s79
    s_cselect_b32 s79, 1, 0
    s_mul_i32 s14, s14, 3
    s_min_u32 s7, s7, s14
    s_add_u32 s7, s7, s15
    s_and_b32 s13, s6, 7
    s_lshr_b32 s14, s5, 1
    s_and_b32 s15, s4, 1
    s_lshl1_add_u32 s14, s14, s15
    s_lshl_b32 s64, s14, 17
    s_and_b32 s14, s5, 1
    s_lshr_b32 s15, s4, 1
    s_lshl1_add_u32 s14, s14, s15
    s_lshl_b32 s14, s14, 13
    s_add_u32 s64, s64, s14
    s_mul_i32 s65, s4, 44032
    s_lshl_b32 s15, s7, 6
    s_add_u32 s65, s65, s15
    s_lshl_b32 s66, s4, 12
    s_mul_i32 s67, s4, 3072
    s_add_u32 s67, s67, 16384
    v_lshrrev_b32 v30, 3, v1
    v_lshlrev_b32 v30, 10, v30
    v_lshrrev_b32 v31, 4, v1
    v_and_b32 v3, 7, v1
    v_xor_b32 v3, v3, v31
    v_lshl_add_u32 v4, v3, 4, v30
    v_xor_b32 v5, 64, v4
    v_add_u32 v5, 31744, v5
    v_add_u32 v6, 63488, v4
    v_add_u32 v7, 63488, v5
    s_cmp_eq_u32 s79, 1
    s_cselect_b32 s14, 8, 12
    v_mov_b32 v15, 0x40000000
    v_add_u32 v30, 0, v1
    v_mul_u32_u24 v31, 0x5556, v30
    v_lshrrev_b32 v31, 18, v31
    v_mad_i32_i24 v3, v31, -12, v30
    v_mul_u32_u24 v31, 2752, v31
    v_lshl_add_u32 v31, v3, 4, v31
    v_cmp_gt_u32 vcc, s14, v3
    v_subrev_u32 v31, 0, v31
    s_nop 0
    v_cndmask_b32 v8, v15, v31, vcc
    v_add_u32 v30, 64, v1
    v_mul_u32_u24 v31, 0x5556, v30
    v_lshrrev_b32 v31, 18, v31
    v_mad_i32_i24 v3, v31, -12, v30
    v_mul_u32_u24 v31, 2752, v31
    v_lshl_add_u32 v31, v3, 4, v31
    v_cmp_gt_u32 vcc, s14, v3
    v_subrev_u32 v31, 1024, v31
    s_nop 0
    v_cndmask_b32 v9, v15, v31, vcc
    v_add_u32 v30, 128, v1
    v_mul_u32_u24 v31, 0x5556, v30
    v_lshrrev_b32 v31, 18, v31
    v_mad_i32_i24 v3, v31, -12, v30
    v_mul_u32_u24 v31, 2752, v31
    v_lshl_add_u32 v31, v3, 4, v31
    v_cmp_gt_u32 vcc, s14, v3
    v_subrev_u32 v31, 2048, v31
    s_nop 0
    v_cndmask_b32 v10, v15, v31, vcc
    s_add_u32 s14, s13, 0
    s_and_b32 s14, s14, 7
    s_lshl_b32 s15, s14, 7
    s_add_u32 s15, s15, s64
    s_add_u32 m0, s66, 0
    s_mul_i32 s17, s14, 176128
    buffer_load_dwordx4 v4, s[28:31], s15 offen offset:0  lds
    buffer_load_dwordx4 v5, s[28:31], s15 offen offset:1024  lds
    buffer_load_dwordx4 v6, s[28:31], s15 offen offset:2048  lds
    buffer_load_dwordx4 v7, s[28:31], s15 offen offset:3072  lds
    s_mov_b32 s54, 1024
    s_mov_b32 s55, 0x20000
    s_mov_b32 s62, 16777216
    s_mov_b32 s63, 0x20000
    v_mov_b32 v71, 13041664
    s_lshl2_add_u32 s26, s4, 8192
    v_mov_b32 v13, s26
    buffer_load_dwordx4 v[56:59], v2, s[52:55], 0 offen
    buffer_load_dword v70, v71, s[60:63], 0 offen sc1
    v_and_b32 v30, 15, v1
    s_lshl_b32 s26, s4, 4
    v_add_u32 v28, s26, v30
    v_cvt_f32_u32 v28, v28
    v_lshrrev_b32 v29, 4, v1
    v_cvt_f32_u32 v29, v29
    v_mul_f32 v152, 0x3c800000, v28
    v_mul_f32 v153, 4.0, v29
    v_mul_f32 v153, v153, v152
    s_mov_b32 s26, 0x80008000
    s_barrier
    s_add_u32 m0, s67, 0
    s_add_u32 s17, s17, s65
    buffer_load_dwordx4 v8, s[40:43], s17 offen offset:0  lds
    buffer_load_dwordx4 v9, s[40:43], s17 offen offset:1024  lds
    buffer_load_dwordx4 v10, s[40:43], s17 offen offset:2048  lds
    s_add_u32 s14, s13, 1
    s_and_b32 s14, s14, 7
    s_lshl_b32 s15, s14, 7
    s_add_u32 s15, s15, s64
    s_add_u32 m0, s66, 28672
    s_mul_i32 s17, s14, 176128
    buffer_load_dwordx4 v4, s[28:31], s15 offen offset:0  lds
    buffer_load_dwordx4 v5, s[28:31], s15 offen offset:1024  lds
    buffer_load_dwordx4 v6, s[28:31], s15 offen offset:2048  lds
    buffer_load_dwordx4 v7, s[28:31], s15 offen offset:3072  lds
    s_add_u32 m0, s67, 28672
    s_add_u32 s17, s17, s65
    buffer_load_dwordx4 v8, s[40:43], s17 offen offset:0  lds
    buffer_load_dwordx4 v9, s[40:43], s17 offen offset:1024  lds
    buffer_load_dwordx4 v10, s[40:43], s17 offen offset:2048  lds
    v_and_b32 v14, 3, v1
    v_lshlrev_b32 v14, 2, v14
    v_add_u32 v14, 8192, v14
    s_lshl_b32 s18, s4, 11
    s_add_u32 s18, s18, 147456
    v_add_u32 v30, s18, v2
    ds_read_b128 v[60:63], v30 offset:0
    ds_read_b128 v[64:67], v30 offset:1024
    s_waitcnt vmcnt(11) lgkmcnt(0)
    v_mov_b32 v68, 0
    v_mov_b32 v69, 0
    v_dot2c_f32_bf16 v68, v60, v56
    v_dot2c_f32_bf16 v69, v64, v56
    v_dot2c_f32_bf16 v68, v61, v57
    v_dot2c_f32_bf16 v69, v65, v57
    v_dot2c_f32_bf16 v68, v62, v58
    v_dot2c_f32_bf16 v69, v66, v58
    v_dot2c_f32_bf16 v68, v63, v59
    v_dot2c_f32_bf16 v69, v67, v59
    s_and_b32 s18, s8, 3
    s_bfe_u32 s19, s8, 0x40002
    s_lshl4_add_u32 s18, s18, s19
    s_and_b32 s19, s4, 1
    s_lshl1_add_u32 s18, s18, s19
    s_lshr_b32 s19, s8, 6
    s_lshr_b32 s27, s4, 1
    s_lshl1_add_u32 s19, s19, s27
    s_lshl_b32 s19, s19, 10
    s_lshl3_add_u32 s27, s18, s19
    v_cmp_eq_u32 vcc, 63, v1
    v_mov_b32 v30, 0x40000000
    v_mov_b32 v3, 12582912
    v_cndmask_b32 v30, v30, v3, vcc
    v_add_f32_dpp v68, v68, v68 row_shr:1 row_mask:0xf bank_mask:0xf bound_ctrl:0
    v_add_f32_dpp v69, v69, v69 row_shr:1 row_mask:0xf bank_mask:0xf bound_ctrl:0
    s_nop 0
    v_add_f32_dpp v68, v68, v68 row_shr:2 row_mask:0xf bank_mask:0xf bound_ctrl:0
    v_add_f32_dpp v69, v69, v69 row_shr:2 row_mask:0xf bank_mask:0xf bound_ctrl:0
    s_nop 0
    v_add_f32_dpp v68, v68, v68 row_shr:4 row_mask:0xf bank_mask:0xf bound_ctrl:0
    v_add_f32_dpp v69, v69, v69 row_shr:4 row_mask:0xf bank_mask:0xf bound_ctrl:0
    s_nop 0
    v_add_f32_dpp v68, v68, v68 row_shr:8 row_mask:0xf bank_mask:0xf bound_ctrl:0
    v_add_f32_dpp v69, v69, v69 row_shr:8 row_mask:0xf bank_mask:0xf bound_ctrl:0
    s_nop 0
    v_add_f32_dpp v68, v68, v68 row_bcast:15 row_mask:0xa bank_mask:0xf
    v_add_f32_dpp v69, v69, v69 row_bcast:15 row_mask:0xa bank_mask:0xf
    s_nop 0
    v_add_f32_dpp v68, v68, v68 row_bcast:31 row_mask:0xc bank_mask:0xf
    v_add_f32_dpp v69, v69, v69 row_bcast:31 row_mask:0xc bank_mask:0xf
    s_mov_b32 s18, 0x42700000
    v_med3_f32 v68, v68, s18, -s18
    v_med3_f32 v69, v69, s18, -s18
    v_mul_f32 v68, 0x3fb8aa3b, v68
    v_mul_f32 v69, 0x3fb8aa3b, v69
    v_exp_f32 v68, v68
    v_exp_f32 v69, v69
    v_lshrrev_b32 v18, 2, v0
    v_lshlrev_b32 v18, 15, v18
    v_and_b32 v19, 3, v0
    v_lshl_add_u32 v18, v19, 4, v18
    s_lshl_b32 s18, s8, 6
    s_add_u32 s18, s18, 2097152
    s_add_u32 s19, s18, 16384
    s_mov_b32 s24, 0x05040100
    s_mov_b32 s25, 0x07060302
    s_mov_b32 vcc_lo, 0x33333333
    s_mov_b32 vcc_hi, 0x33333333
    v_perm_b32 v40, v36, v32, s24
    v_perm_b32 v41, v37, v33, s24
    v_perm_b32 v42, v38, v34, s24
    v_perm_b32 v43, v39, v35, s24
    v_perm_b32 v44, v36, v32, s25
    v_perm_b32 v45, v37, v33, s25
    v_perm_b32 v46, v38, v34, s25
    v_perm_b32 v47, v39, v35, s25
    v_cndmask_b32_dpp v32, v44, v40, vcc quad_perm:[2,3,0,1] row_mask:0xf bank_mask:0xf
    v_cndmask_b32_dpp v33, v45, v41, vcc quad_perm:[2,3,0,1] row_mask:0xf bank_mask:0xf
    v_cndmask_b32_dpp v34, v46, v42, vcc quad_perm:[2,3,0,1] row_mask:0xf bank_mask:0xf
    v_cndmask_b32_dpp v35, v47, v43, vcc quad_perm:[2,3,0,1] row_mask:0xf bank_mask:0xf
    buffer_store_dwordx4 v[32:35], v18, s[60:63], s18 offen sc1
    s_not_b64 vcc, vcc
    v_cndmask_b32_dpp v36, v40, v44, vcc quad_perm:[2,3,0,1] row_mask:0xf bank_mask:0xf
    v_cndmask_b32_dpp v37, v41, v45, vcc quad_perm:[2,3,0,1] row_mask:0xf bank_mask:0xf
    v_cndmask_b32_dpp v38, v42, v46, vcc quad_perm:[2,3,0,1] row_mask:0xf bank_mask:0xf
    v_cndmask_b32_dpp v39, v43, v47, vcc quad_perm:[2,3,0,1] row_mask:0xf bank_mask:0xf
    v_lshl_or_b32 v48, v49, 16, v48
    v_lshlrev_b32 v19, 2, v0
    v_cmp_gt_u32 vcc, 8, v0
    v_mov_b32 v17, 0x40000000
    s_lshl_b32 s16, s8, 5
    s_add_u32 s16, s16, 13631488
    v_cndmask_b32 v17, v17, v19, vcc
    buffer_store_dword v48, v17, s[60:63], s16 offen sc1
    buffer_store_dwordx4 v[36:39], v18, s[60:63], s19 offen sc1
    buffer_store_dwordx2 v[68:69], v30, s[60:63], s27 offen sc1
    s_mov_b32 s50, 1409024
    s_mov_b32 s51, 0x20000
    v_min_u32 v17, 10, v1
    v_lshlrev_b32 v17, 7, v17
    s_mul_i32 s18, s2, 5504
    s_mul_i32 s19, s4, 1408
    s_add_u32 s18, s18, s19
    buffer_load_dword v50, v17, s[48:51], s18 offen
    s_waitcnt vmcnt(15)
    v_readfirstlane_b32 s12, v70
    s_nop 0
    s_add_u32 s12, s12, 4
    s_waitcnt vmcnt(12)
    s_barrier
    s_add_u32 s14, s13, 2
    s_and_b32 s14, s14, 7
    s_lshl_b32 s15, s14, 7
    s_add_u32 s15, s15, s64
    s_add_u32 m0, s66, 57344
    s_mul_i32 s17, s14, 176128
    buffer_load_dwordx4 v4, s[28:31], s15 offen offset:0  lds
    s_mov_b32 s50, 1409024
    s_mov_b32 s51, 0x20000
    s_mov_b32 s58, 2097152
    s_mov_b32 s59, 0x20000
    s_and_b32 s18, s2, 7
    s_lshr_b32 s19, s2, 3
    s_xor_b32 s19, s19, 0
    s_lshl_b32 s18, s18, 5
    s_add_u32 s11, s18, s19
    buffer_load_dwordx4 v5, s[28:31], s15 offen offset:1024  lds
    s_mov_b32 s14, s9
    s_and_b32 s14, s14, 7
    s_mul_i32 s14, s14, 5
    s_add_u32 s14, s14, s4
    v_lshl_add_u32 v30, v1, 2, s14
    v_subrev_u32 v3, 43, v30
    v_min_u32 v30, v30, v3
    s_lshl_b32 s14, s10, 7
    s_lshl_b32 s70, s4, 12
    v_lshl_add_u32 v15, v30, 15, s14
    s_waitcnt vmcnt(13)
    buffer_load_dwordx4 v6, s[28:31], s15 offen offset:2048  lds
    v_lshrrev_b32 v30, 3, v1
    v_lshlrev_b32 v30, 10, v30
    v_and_b32 v3, 7, v1
    v_lshrrev_b32 v31, 2, v1
    v_and_b32 v31, 4, v31
    v_xor_b32 v3, v3, v31
    v_lshl_add_u32 v60, v3, 4, v30
    v_add_u32 v61, 7168, v60
    v_add_u32 v62, 14336, v60
    v_add_u32 v63, 21504, v60
    s_waitcnt vmcnt(13)
    buffer_load_dwordx4 v7, s[28:31], s15 offen offset:3072  lds
    s_add_u32 m0, s67, 57344
    s_add_u32 s17, s17, s65
    s_waitcnt vmcnt(13)
    buffer_load_dwordx4 v8, s[40:43], s17 offen offset:0  lds
    s_waitcnt vmcnt(13)
    buffer_load_dwordx4 v9, s[40:43], s17 offen offset:1024  lds
    s_waitcnt vmcnt(13)
    buffer_load_dwordx4 v10, s[40:43], s17 offen offset:2048  lds
    s_waitcnt vmcnt(12)
    s_barrier
    s_add_u32 s14, s13, 3
    s_and_b32 s14, s14, 7
    s_lshl_b32 s15, s14, 7
    s_add_u32 s15, s15, s64
    s_add_u32 m0, s66, 86016
    s_mul_i32 s17, s14, 176128
    buffer_load_dwordx4 v4, s[28:31], s15 offen offset:0  lds
    v_mov_b32 v136, v153
    v_add_f32 v137, v152, v153
    v_fmamk_f32 v138, v152, 0x40000000, v153
    v_fmamk_f32 v139, v152, 0x40400000, v153
    v_fmamk_f32 v140, v152, 0x41800000, v153
    buffer_load_dwordx4 v5, s[28:31], s15 offen offset:1024  lds
    v_fmamk_f32 v141, v152, 0x41880000, v153
    v_fmamk_f32 v142, v152, 0x41900000, v153
    v_fmamk_f32 v143, v152, 0x41980000, v153
    v_sin_f32 v144, v136
    v_cos_f32 v136, v136
    s_waitcnt vmcnt(9)
    buffer_load_dwordx4 v6, s[28:31], s15 offen offset:2048  lds
    v_sin_f32 v145, v137
    v_cos_f32 v137, v137
    v_sin_f32 v146, v138
    v_cos_f32 v138, v138
    v_sin_f32 v147, v139
    s_waitcnt vmcnt(9)
    buffer_load_dwordx4 v7, s[28:31], s15 offen offset:3072  lds
    v_cos_f32 v139, v139
    v_sin_f32 v148, v140
    v_cos_f32 v140, v140
    v_sin_f32 v149, v141
    v_cos_f32 v141, v141
    s_add_u32 m0, s67, 86016
    s_add_u32 s17, s17, s65
    s_waitcnt vmcnt(9)
    buffer_load_dwordx4 v8, s[40:43], s17 offen offset:0  lds
    v_sin_f32 v150, v142
    v_cos_f32 v142, v142
    v_sin_f32 v151, v143
    v_cos_f32 v143, v143
    v_cvt_pk_bf16_f32 v72, v136, v137
    s_waitcnt vmcnt(9)
    buffer_load_dwordx4 v9, s[40:43], s17 offen offset:1024  lds
    v_cvt_pk_bf16_f32 v88, v144, v145
    v_cvt_pk_bf16_f32 v73, v138, v139
    v_cvt_pk_bf16_f32 v89, v146, v147
    v_cvt_pk_bf16_f32 v74, v140, v141
    v_cvt_pk_bf16_f32 v90, v148, v149
    s_waitcnt vmcnt(9)
    buffer_load_dwordx4 v10, s[40:43], s17 offen offset:2048  lds
    s_waitcnt vmcnt(7)
    s_barrier
    s_lshl_b32 s18, s8, 4
    v_cmp_eq_u32 vcc, 0, v0
    v_mov_b32 v30, 0x40000000
    v_mov_b32 v3, 12648448
    v_cndmask_b32 v30, v30, v3, vcc
    v_mov_b32 v3, s12
    buffer_store_dword v3, v30, s[60:63], s18 offen sc1
    v_cvt_pk_bf16_f32 v75, v142, v143
    v_cvt_pk_bf16_f32 v91, v150, v151
    v_xor_b32 v80, s26, v88
    v_xor_b32 v81, s26, v89
    v_xor_b32 v82, s26, v90
    s_add_u32 s14, s13, 4
    s_and_b32 s14, s14, 7
    s_lshl_b32 s15, s14, 7
    s_add_u32 s15, s15, s64
    s_add_u32 m0, s66, 0
    s_mul_i32 s17, s14, 176128
    buffer_load_dwordx4 v4, s[28:31], s15 offen offset:0  lds
    v_xor_b32 v83, s26, v91
    v_fmamk_f32 v136, v152, 0x42000000, v153
    v_fmamk_f32 v137, v152, 0x42040000, v153
    v_fmamk_f32 v138, v152, 0x42080000, v153
    v_fmamk_f32 v139, v152, 0x420c0000, v153
    buffer_load_dwordx4 v5, s[28:31], s15 offen offset:1024  lds
    v_lshrrev_b32 v3, 4, v1
    v_xor_b32 v71, v1, v3
    v_lshlrev_b32 v71, 4, v71
    s_and_b32 s19, s11, 1
    s_lshl_b32 s18, s19, 1
    v_bfe_u32 v3, v1, 2, 2
    v_xor_b32 v3, s18, v3
    v_lshlrev_b32 v3, 4, v3
    v_lshl_add_u32 v3, v1, 6, v3
    v_add_u32 v12, 147456, v3
    s_lshl_b32 s18, s4, 12
    s_lshl_b32 s19, s19, 5
    v_lshlrev_b32 v70, 5, v1
    v_and_b32 v3, 1, v1
    v_lshlrev_b32 v3, 4, v3
    v_sub_u32 v70, v70, v3
    s_lshr_b32 s74, s11, 1
    s_lshl_b32 s74, s74, 14
    s_add_u32 s74, s74, s18
    s_add_u32 s75, s74, s19
    s_add_u32 s75, s75, 2097152
    s_lshl_b32 s76, s4, 11
    s_add_u32 s76, s76, 12582912
    v_fmamk_f32 v140, v152, 0x42400000, v153
    v_fmamk_f32 v141, v152, 0x42440000, v153
    v_fmamk_f32 v142, v152, 0x42480000, v153
    v_fmamk_f32 v143, v152, 0x424c0000, v153
    v_sin_f32 v144, v136
    buffer_load_dwordx4 v6, s[28:31], s15 offen offset:2048  lds
    v_cos_f32 v136, v136
    v_sin_f32 v145, v137
    v_cos_f32 v137, v137
    v_sin_f32 v146, v138
    v_cos_f32 v138, v138
    s_waitcnt vmcnt(10)
    buffer_load_dwordx4 v7, s[28:31], s15 offen offset:3072  lds
    v_sin_f32 v147, v139
    v_cos_f32 v139, v139
    v_sin_f32 v148, v140
    v_cos_f32 v140, v140
    v_sin_f32 v149, v141
    s_add_u32 m0, s67, 0
    s_add_u32 s17, s17, s65
    s_waitcnt vmcnt(10)
    buffer_load_dwordx4 v8, s[40:43], s17 offen offset:0  lds
    v_cos_f32 v141, v141
    v_sin_f32 v150, v142
    v_cos_f32 v142, v142
    v_sin_f32 v151, v143
    v_cos_f32 v143, v143
    s_waitcnt vmcnt(10)
    buffer_load_dwordx4 v9, s[40:43], s17 offen offset:1024  lds
    v_cvt_pk_bf16_f32 v76, v136, v137
    v_cvt_pk_bf16_f32 v92, v144, v145
    v_cvt_pk_bf16_f32 v77, v138, v139
    v_cvt_pk_bf16_f32 v93, v146, v147
    v_cvt_pk_bf16_f32 v78, v140, v141
    s_waitcnt vmcnt(10)
    buffer_load_dwordx4 v10, s[40:43], s17 offen offset:2048  lds
    s_waitcnt vmcnt(8)
    s_barrier
    v_cvt_pk_bf16_f32 v94, v148, v149
    v_cvt_pk_bf16_f32 v79, v142, v143
    v_cvt_pk_bf16_f32 v95, v150, v151
    v_xor_b32 v84, s26, v92
    v_xor_b32 v85, s26, v93
    s_add_u32 s14, s13, 5
    s_and_b32 s14, s14, 7
    s_lshl_b32 s15, s14, 7
    s_add_u32 s15, s15, s64
    s_add_u32 m0, s66, 28672
    s_mul_i32 s17, s14, 176128
    buffer_load_dwordx4 v4, s[28:31], s15 offen offset:0  lds
    v_xor_b32 v86, s26, v94
    v_xor_b32 v87, s26, v95
    v_mul_f32 v152, 0x3a000000, v28
    v_mul_f32 v29, 0x41000000, v29
    v_mul_f32 v153, v29, v152
    buffer_load_dwordx4 v5, s[28:31], s15 offen offset:1024  lds
    v_mov_b32 v136, v153
    v_add_f32 v137, v152, v153
    v_fmamk_f32 v138, v152, 0x40000000, v153
    v_fmamk_f32 v139, v152, 0x40400000, v153
    v_fmamk_f32 v140, v152, 0x40800000, v153
    buffer_load_dwordx4 v6, s[28:31], s15 offen offset:2048  lds
    v_fmamk_f32 v141, v152, 0x40a00000, v153
    v_fmamk_f32 v142, v152, 0x40c00000, v153
    v_fmamk_f32 v143, v152, 0x40e00000, v153
    v_cos_f32 v120, v136
    v_sin_f32 v128, v136
    s_waitcnt vmcnt(9)
    buffer_load_dwordx4 v7, s[28:31], s15 offen offset:3072  lds
    v_cos_f32 v121, v137
    v_sin_f32 v129, v137
    v_cos_f32 v122, v138
    v_sin_f32 v130, v138
    v_cos_f32 v123, v139
    s_add_u32 m0, s67, 28672
    s_add_u32 s17, s17, s65
    s_waitcnt vmcnt(9)
    buffer_load_dwordx4 v8, s[40:43], s17 offen offset:0  lds
    v_sin_f32 v131, v139
    v_cos_f32 v124, v140
    v_sin_f32 v132, v140
    v_cos_f32 v125, v141
    v_sin_f32 v133, v141
    s_waitcnt vmcnt(9)
    buffer_load_dwordx4 v9, s[40:43], s17 offen offset:1024  lds
    v_cos_f32 v126, v142
    v_sin_f32 v134, v142
    v_cos_f32 v127, v143
    v_sin_f32 v135, v143
    v_bfe_u32 v28, v1, 2, 2
    s_waitcnt vmcnt(9)
    buffer_load_dwordx4 v10, s[40:43], s17 offen offset:2048  lds
    v_and_b32 v152, 3, v1
    v_lshl_add_u32 v28, v28, 3, v152
    v_cvt_f32_u32 v28, v28
    v_add_f32 v152, 0x00000000, v28
    v_mul_f32 v152, 0x3d000000, v152
    v_readlane_b32 s22, v15, 0
    s_add_u32 m0, s70, 114688
    s_waitcnt vmcnt(9)
    s_nop 2
    buffer_load_dwordx4 v60, s[48:51], s22 offen offset:0  lds
    v_mul_f32 v153, v29, v152
    v_mov_b32 v136, v153
    v_add_f32 v137, v152, v153
    v_fmamk_f32 v138, v152, 0x40000000, v153
    v_fmamk_f32 v139, v152, 0x40400000, v153
    s_waitcnt vmcnt(9)
    buffer_load_dwordx4 v61, s[48:51], s22 offen offset:1024  lds
    v_fmamk_f32 v140, v152, 0x40800000, v153
    v_fmamk_f32 v141, v152, 0x40a00000, v153
    v_fmamk_f32 v142, v152, 0x40c00000, v153
    v_fmamk_f32 v143, v152, 0x40e00000, v153
    v_sin_f32 v144, v136
    s_waitcnt vmcnt(9)
    buffer_load_dwordx4 v62, s[48:51], s22 offen offset:2048  lds
    v_cos_f32 v136, v136
    v_sin_f32 v145, v137
    v_cos_f32 v137, v137
    v_sin_f32 v146, v138
    v_cos_f32 v138, v138
    s_waitcnt vmcnt(9)
    buffer_load_dwordx4 v63, s[48:51], s22 offen offset:3072  lds
    s_barrier
    v_sin_f32 v147, v139
    v_cos_f32 v139, v139
    v_sin_f32 v148, v140
    v_cos_f32 v140, v140
    v_sin_f32 v149, v141
    s_add_u32 s14, s13, 6
    s_and_b32 s14, s14, 7
    s_lshl_b32 s15, s14, 7
    s_add_u32 s15, s15, s64
    s_add_u32 m0, s66, 57344
    s_mul_i32 s17, s14, 176128
    s_waitcnt vmcnt(9)
    buffer_load_dwordx4 v4, s[28:31], s15 offen offset:0  lds
    v_cos_f32 v141, v141
    v_sin_f32 v150, v142
    v_cos_f32 v142, v142
    v_sin_f32 v151, v143
    v_cos_f32 v143, v143
    s_waitcnt vmcnt(9)
    buffer_load_dwordx4 v5, s[28:31], s15 offen offset:1024  lds
    v_cvt_pk_bf16_f32 v96, v136, v137
    v_cvt_pk_bf16_f32 v112, v144, v145
    v_cvt_pk_bf16_f32 v97, v138, v139
    v_cvt_pk_bf16_f32 v113, v146, v147
    v_cvt_pk_bf16_f32 v98, v140, v141
    s_waitcnt vmcnt(9)
    buffer_load_dwordx4 v6, s[28:31], s15 offen offset:2048  lds
    v_cvt_pk_bf16_f32 v114, v148, v149
    v_cvt_pk_bf16_f32 v99, v142, v143
    v_cvt_pk_bf16_f32 v115, v150, v151
    v_xor_b32 v104, s26, v112
    v_xor_b32 v105, s26, v113
    s_waitcnt vmcnt(9)
    buffer_load_dwordx4 v7, s[28:31], s15 offen offset:3072  lds
    v_xor_b32 v106, s26, v114
    v_xor_b32 v107, s26, v115
    v_add_f32 v152, 0x40800000, v28
    v_mul_f32 v152, 0x3d000000, v152
    v_mul_f32 v153, v29, v152
    s_add_u32 m0, s67, 57344
    s_add_u32 s17, s17, s65
    s_waitcnt vmcnt(9)
    buffer_load_dwordx4 v8, s[40:43], s17 offen offset:0  lds
    v_mov_b32 v136, v153
    v_add_f32 v137, v152, v153
    v_fmamk_f32 v138, v152, 0x40000000, v153
    v_fmamk_f32 v139, v152, 0x40400000, v153
    v_fmamk_f32 v140, v152, 0x40800000, v153
    s_waitcnt vmcnt(9)
    buffer_load_dwordx4 v9, s[40:43], s17 offen offset:1024  lds
    v_fmamk_f32 v141, v152, 0x40a00000, v153
    v_fmamk_f32 v142, v152, 0x40c00000, v153
    v_fmamk_f32 v143, v152, 0x40e00000, v153
    v_sin_f32 v144, v136
    v_cos_f32 v136, v136
    s_waitcnt vmcnt(9)
    buffer_load_dwordx4 v10, s[40:43], s17 offen offset:2048  lds
    s_barrier
    s_lshl_b32 s27, s4, 10
    s_add_u32 s27, s27, 12648448
    v_lshlrev_b32 v31, 4, v1
    buffer_load_dword v16, v31, s[60:63], s27 offen sc1
    v_sin_f32 v145, v137
    v_cos_f32 v137, v137
    v_sin_f32 v146, v138
    v_cos_f32 v138, v138
    v_sin_f32 v147, v139
    s_add_u32 s14, s13, 7
    s_and_b32 s14, s14, 7
    s_lshl_b32 s15, s14, 7
    s_add_u32 s15, s15, s64
    s_add_u32 m0, s66, 86016
    s_mul_i32 s17, s14, 176128
    s_waitcnt vmcnt(9)
    buffer_load_dwordx4 v4, s[28:31], s15 offen offset:0  lds
    v_cos_f32 v139, v139
    v_sin_f32 v148, v140
    v_cos_f32 v140, v140
    v_sin_f32 v149, v141
    v_cos_f32 v141, v141
    s_waitcnt vmcnt(9)
    buffer_load_dwordx4 v5, s[28:31], s15 offen offset:1024  lds
    v_sin_f32 v150, v142
    v_cos_f32 v142, v142
    v_sin_f32 v151, v143
    v_cos_f32 v143, v143
    v_cvt_pk_bf16_f32 v100, v136, v137
    s_waitcnt vmcnt(9)
    buffer_load_dwordx4 v6, s[28:31], s15 offen offset:2048  lds
    v_cvt_pk_bf16_f32 v116, v144, v145
    v_cvt_pk_bf16_f32 v101, v138, v139
    v_cvt_pk_bf16_f32 v117, v146, v147
    v_cvt_pk_bf16_f32 v102, v140, v141
    v_cvt_pk_bf16_f32 v118, v148, v149
    s_waitcnt vmcnt(9)
    buffer_load_dwordx4 v7, s[28:31], s15 offen offset:3072  lds
    v_cvt_pk_bf16_f32 v103, v142, v143
    v_cvt_pk_bf16_f32 v119, v150, v151
    v_xor_b32 v108, s26, v116
    v_xor_b32 v109, s26, v117
    v_xor_b32 v110, s26, v118
    s_add_u32 m0, s67, 86016
    s_add_u32 s17, s17, s65
    s_waitcnt vmcnt(9)
    buffer_load_dwordx4 v8, s[40:43], s17 offen offset:0  lds
    v_xor_b32 v111, s26, v119
    s_waitcnt vmcnt(9)
    buffer_load_dwordx4 v9, s[40:43], s17 offen offset:1024  lds
    s_waitcnt vmcnt(9)
    buffer_load_dwordx4 v10, s[40:43], s17 offen offset:2048  lds
    s_waitcnt vmcnt(7)
    v_cmp_ne_u32 vcc, s12, v16
    s_nop 0
    s_cbranch_vccnz L_rare_4
L_back_5:
    s_add_u32 m0, s70, 147456
    v_mov_b32 v10, 1
    buffer_load_dwordx4 v71, s[60:63], s74 offen offset:0 sc1 lds
    buffer_load_dwordx4 v71, s[60:63], s74 offen offset:1024 sc1 lds
    buffer_load_dwordx4 v71, s[60:63], s74 offen offset:2048 sc1 lds
    buffer_load_dwordx4 v71, s[60:63], s74 offen offset:3072 sc1 lds
    s_barrier
    v_lshlrev_b32 v30, 2, v1
    v_mov_b32 v17, 0
    ds_write_b32 v30, v17 offset:8192
    buffer_load_dwordx4 v[168:171], v70, s[60:63], s75 offen offset:0 sc1
    buffer_load_dwordx4 v[172:175], v70, s[60:63], s75 offen offset:2048 sc1
    buffer_load_dwordx4 v[20:23], v2, s[60:63], s76 offen offset:0 sc1
    buffer_load_dwordx4 v[24:27], v2, s[60:63], s76 offen offset:1024 sc1
    s_waitcnt lgkmcnt(0)
    s_waitcnt vmcnt(8)
    s_barrier
    v_xor_b32 v30, 16, v12
    s_barrier
    v_readlane_b32 s23, v15, 1
    s_add_u32 m0, s70, 131072
    s_nop 3
    buffer_load_dwordx4 v60, s[48:51], s23 offen offset:0  lds
    buffer_load_dwordx4 v61, s[48:51], s23 offen offset:1024  lds
    buffer_load_dwordx4 v62, s[48:51], s23 offen offset:2048  lds
    buffer_load_dwordx4 v63, s[48:51], s23 offen offset:3072  lds
    s_setprio 1
    s_waitcnt vmcnt(8)
    ds_write_b32 v13, v10 offset:0
    s_mov_b32 s14, 0
L_bs_7:
    ds_read_b32 v3, v14 offset:0
    s_add_u32 s14, s14, 1
    s_waitcnt lgkmcnt(0)
    v_cmp_ne_u32 vcc, 1, v3
    s_cmp_gt_u32 s14, 2000000
    s_cbranch_scc1 L_bse_8
    s_cbranch_vccnz L_bs_7
L_bse_8:
    s_cmp_eq_u32 s11, 0
    s_cbranch_scc1 L_sp_9
    s_nop 7
    ds_read_b64_tr_b16 v[136:137], v12 offset:0
    ds_read_b64_tr_b16 v[138:139], v12 offset:4096
    ds_read_b64_tr_b16 v[152:153], v30 offset:0
    ds_read_b64_tr_b16 v[154:155], v30 offset:4096
    ds_read_b64_tr_b16 v[144:145], v12 offset:8
    ds_read_b64_tr_b16 v[146:147], v12 offset:4104
    ds_read_b64_tr_b16 v[160:161], v30 offset:8
    ds_read_b64_tr_b16 v[162:163], v30 offset:4104
    ds_read_b64_tr_b16 v[140:141], v12 offset:8192
    ds_read_b64_tr_b16 v[142:143], v12 offset:12288
    ds_read_b64_tr_b16 v[156:157], v30 offset:8192
    ds_read_b64_tr_b16 v[158:159], v30 offset:12288
    ds_read_b64_tr_b16 v[148:149], v12 offset:8200
    ds_read_b64_tr_b16 v[150:151], v12 offset:12296
    s_waitcnt lgkmcnt(14)
    ds_read_b64_tr_b16 v[164:165], v30 offset:8200
    s_waitcnt lgkmcnt(14)
    ds_read_b64_tr_b16 v[166:167], v30 offset:12296
    s_waitcnt lgkmcnt(14)
    v_mfma_f32_16x16x32_bf16 v[32:35], v[136:139], v[72:75], 0
    v_mfma_f32_16x16x32_bf16 v[40:43], v[136:139], v[80:83], 0
    s_waitcnt lgkmcnt(12)
    v_mfma_f32_16x16x32_bf16 v[32:35], v[152:155], v[88:91], v[32:35]
    v_mfma_f32_16x16x32_bf16 v[40:43], v[152:155], v[72:75], v[40:43]
    s_waitcnt lgkmcnt(10)
    v_mfma_f32_16x16x32_bf16 v[36:39], v[144:147], v[72:75], 0
    v_mfma_f32_16x16x32_bf16 v[44:47], v[144:147], v[80:83], 0
    s_waitcnt lgkmcnt(8)
    v_mfma_f32_16x16x32_bf16 v[36:39], v[160:163], v[88:91], v[36:39]
    v_mfma_f32_16x16x32_bf16 v[44:47], v[160:163], v[72:75], v[44:47]
    s_waitcnt lgkmcnt(6)
    v_mfma_f32_16x16x32_bf16 v[32:35], v[140:143], v[76:79], v[32:35]
    v_mfma_f32_16x16x32_bf16 v[40:43], v[140:143], v[84:87], v[40:43]
    s_waitcnt lgkmcnt(4)
    v_mfma_f32_16x16x32_bf16 v[32:35], v[156:159], v[92:95], v[32:35]
    v_mfma_f32_16x16x32_bf16 v[40:43], v[156:159], v[76:79], v[40:43]
    s_waitcnt lgkmcnt(2)
    v_mfma_f32_16x16x32_bf16 v[36:39], v[148:151], v[76:79], v[36:39]
    v_mfma_f32_16x16x32_bf16 v[44:47], v[148:151], v[84:87], v[44:47]
    s_waitcnt lgkmcnt(0)
    v_mfma_f32_16x16x32_bf16 v[36:39], v[164:167], v[92:95], v[36:39]
    v_mfma_f32_16x16x32_bf16 v[44:47], v[164:167], v[76:79], v[44:47]
    s_waitcnt vmcnt(6)
    v_lshlrev_b32 v56, 16, v168
    v_and_b32 v168, 0xffff0000, v168
    v_lshlrev_b32 v57, 16, v169
    v_and_b32 v169, 0xffff0000, v169
    v_lshlrev_b32 v58, 16, v170
    v_and_b32 v170, 0xffff0000, v170
    v_lshlrev_b32 v59, 16, v171
    v_and_b32 v171, 0xffff0000, v171
    v_lshlrev_b32 v60, 16, v172
    v_and_b32 v172, 0xffff0000, v172
    v_lshlrev_b32 v61, 16, v173
    v_and_b32 v173, 0xffff0000, v173
    v_lshlrev_b32 v62, 16, v174
    v_and_b32 v174, 0xffff0000, v174
    v_lshlrev_b32 v63, 16, v175
    v_and_b32 v175, 0xffff0000, v175
    v_pk_mul_f32 v[16:17], v[32:33], v[128:129]
    v_pk_mul_f32 v[32:33], v[32:33], v[120:121]
    v_pk_fma_f32 v[32:33], v[40:41], v[128:129], v[32:33]
    v_pk_fma_f32 v[40:41], v[40:41], v[120:121], v[16:17] neg_lo:[0,0,1] neg_hi:[0,0,1]
    v_pk_mul_f32 v[18:19], v[34:35], v[130:131]
    v_pk_mul_f32 v[34:35], v[34:35], v[122:123]
    v_pk_fma_f32 v[34:35], v[42:43], v[130:131], v[34:35]
    v_pk_fma_f32 v[42:43], v[42:43], v[122:123], v[18:19] neg_lo:[0,0,1] neg_hi:[0,0,1]
    v_pk_mul_f32 v[16:17], v[36:37], v[132:133]
    v_pk_mul_f32 v[36:37], v[36:37], v[124:125]
    v_pk_fma_f32 v[36:37], v[44:45], v[132:133], v[36:37]
    v_pk_fma_f32 v[44:45], v[44:45], v[124:125], v[16:17] neg_lo:[0,0,1] neg_hi:[0,0,1]
    v_pk_mul_f32 v[18:19], v[38:39], v[134:135]
    v_pk_mul_f32 v[38:39], v[38:39], v[126:127]
    v_pk_fma_f32 v[38:39], v[46:47], v[134:135], v[38:39]
    v_pk_fma_f32 v[46:47], v[46:47], v[126:127], v[18:19] neg_lo:[0,0,1] neg_hi:[0,0,1]
    v_cvt_pk_bf16_f32 v48, v32, v33
    v_cvt_pk_bf16_f32 v49, v34, v35
    v_cvt_pk_bf16_f32 v50, v36, v37
    v_cvt_pk_bf16_f32 v51, v38, v39
    v_cvt_pk_bf16_f32 v52, v40, v41
    v_cvt_pk_bf16_f32 v53, v42, v43
    v_cvt_pk_bf16_f32 v54, v44, v45
    v_cvt_pk_bf16_f32 v55, v46, v47
    v_mfma_f32_16x16x32_bf16 v[136:139], v[96:99], v[48:51], 0
    v_mfma_f32_16x16x32_bf16 v[144:147], v[104:107], v[48:51], 0
    v_mfma_f32_16x16x32_bf16 v[136:139], v[112:115], v[52:55], v[136:139]
    v_mfma_f32_16x16x32_bf16 v[144:147], v[96:99], v[52:55], v[144:147]
    v_mfma_f32_16x16x32_bf16 v[140:143], v[100:103], v[48:51], 0
    v_mfma_f32_16x16x32_bf16 v[148:151], v[108:111], v[48:51], 0
    v_mfma_f32_16x16x32_bf16 v[140:143], v[116:119], v[52:55], v[140:143]
    v_mfma_f32_16x16x32_bf16 v[148:151], v[100:103], v[52:55], v[148:151]
    v_and_b32 v31, 15, v1
    v_lshlrev_b32 v31, 6, v31
    v_lshrrev_b32 v29, 4, v1
    v_lshl_add_u32 v31, v29, 4, v31
    s_lshl_b32 s14, s4, 10
    v_add_u32 v31, s14, v31
    v_pk_mul_f32 v[16:17], v[136:137], v[168:169]
    v_pk_mul_f32 v[136:137], v[136:137], v[56:57]
    v_pk_fma_f32 v[136:137], v[144:145], v[168:169], v[136:137] neg_lo:[1,0,0] neg_hi:[1,0,0]
    v_pk_fma_f32 v[144:145], v[144:145], v[56:57], v[16:17]
    v_pk_mul_f32 v[18:19], v[138:139], v[170:171]
    v_pk_mul_f32 v[138:139], v[138:139], v[58:59]
    v_pk_fma_f32 v[138:139], v[146:147], v[170:171], v[138:139] neg_lo:[1,0,0] neg_hi:[1,0,0]
    v_pk_fma_f32 v[146:147], v[146:147], v[58:59], v[18:19]
    v_pk_mul_f32 v[16:17], v[140:141], v[172:173]
    v_pk_mul_f32 v[140:141], v[140:141], v[60:61]
    v_pk_fma_f32 v[140:141], v[148:149], v[172:173], v[140:141] neg_lo:[1,0,0] neg_hi:[1,0,0]
    v_pk_fma_f32 v[148:149], v[148:149], v[60:61], v[16:17]
    v_pk_mul_f32 v[18:19], v[142:143], v[174:175]
    v_pk_mul_f32 v[142:143], v[142:143], v[62:63]
    v_pk_fma_f32 v[142:143], v[150:151], v[174:175], v[142:143] neg_lo:[1,0,0] neg_hi:[1,0,0]
    v_pk_fma_f32 v[150:151], v[150:151], v[62:63], v[18:19]
    v_cvt_pk_bf16_f32 v48, v136, v137
    v_cvt_pk_bf16_f32 v49, v138, v139
    v_cvt_pk_bf16_f32 v50, v140, v141
    v_cvt_pk_bf16_f32 v51, v142, v143
    v_cvt_pk_bf16_f32 v52, v144, v145
    v_cvt_pk_bf16_f32 v53, v146, v147
    v_cvt_pk_bf16_f32 v54, v148, v149
    v_cvt_pk_bf16_f32 v55, v150, v151
    v_mfma_f32_16x16x32_bf16 v[32:35], v[96:99], v[48:51], 0
    v_mfma_f32_16x16x32_bf16 v[40:43], v[112:115], v[48:51], 0
    v_mfma_f32_16x16x32_bf16 v[32:35], v[104:107], v[52:55], v[32:35]
    v_mfma_f32_16x16x32_bf16 v[40:43], v[96:99], v[52:55], v[40:43]
    v_mfma_f32_16x16x32_bf16 v[36:39], v[100:103], v[48:51], 0
    v_mfma_f32_16x16x32_bf16 v[44:47], v[116:119], v[48:51], 0
    v_mfma_f32_16x16x32_bf16 v[36:39], v[108:111], v[52:55], v[36:39]
    v_mfma_f32_16x16x32_bf16 v[44:47], v[100:103], v[52:55], v[44:47]
    v_bfe_u32 v28, v1, 3, 1
    v_lshl_add_u32 v28, v28, 2, v29
    v_lshlrev_b32 v28, 16, v28
    v_and_b32 v29, 7, v1
    v_lshl_add_u32 v28, v29, 4, v28
    s_lshl_b32 s16, s4, 19
    s_lshl_b32 s15, s11, 8
    s_add_u32 s16, s16, s15
    s_add_u32 s16, s16, 4194304
    v_pk_mul_f32 v[16:17], v[32:33], v[128:129]
    v_pk_mul_f32 v[32:33], v[32:33], v[120:121]
    v_pk_fma_f32 v[32:33], v[40:41], v[128:129], v[32:33] neg_lo:[1,0,0] neg_hi:[1,0,0]
    v_pk_fma_f32 v[40:41], v[40:41], v[120:121], v[16:17]
    v_pk_mul_f32 v[18:19], v[34:35], v[130:131]
    v_pk_mul_f32 v[34:35], v[34:35], v[122:123]
    v_pk_fma_f32 v[34:35], v[42:43], v[130:131], v[34:35] neg_lo:[1,0,0] neg_hi:[1,0,0]
    v_pk_fma_f32 v[42:43], v[42:43], v[122:123], v[18:19]
    v_pk_mul_f32 v[16:17], v[36:37], v[132:133]
    v_pk_mul_f32 v[36:37], v[36:37], v[124:125]
    v_pk_fma_f32 v[36:37], v[44:45], v[132:133], v[36:37] neg_lo:[1,0,0] neg_hi:[1,0,0]
    v_pk_fma_f32 v[44:45], v[44:45], v[124:125], v[16:17]
    v_pk_mul_f32 v[18:19], v[38:39], v[134:135]
    v_pk_mul_f32 v[38:39], v[38:39], v[126:127]
    v_pk_fma_f32 v[38:39], v[46:47], v[134:135], v[38:39] neg_lo:[1,0,0] neg_hi:[1,0,0]
    v_pk_fma_f32 v[46:47], v[46:47], v[126:127], v[18:19]
    v_cvt_pk_bf16_f32 v48, v32, v33
    v_cvt_pk_bf16_f32 v49, v34, v35
    v_cvt_pk_bf16_f32 v50, v36, v37
    v_cvt_pk_bf16_f32 v51, v38, v39
    v_cvt_pk_bf16_f32 v52, v40, v41
    v_cvt_pk_bf16_f32 v53, v42, v43
    v_cvt_pk_bf16_f32 v54, v44, v45
    v_cvt_pk_bf16_f32 v55, v46, v47
    ds_write_b128 v31, v[48:51] offset:0
    ds_write_b128 v31, v[52:55] offset:4096
    s_waitcnt lgkmcnt(0)
    ds_write_b32 v13, v10 offset:16
    s_mov_b32 s14, 0
L_bs_16:
    ds_read_b32 v3, v14 offset:16
    s_add_u32 s14, s14, 1
    s_waitcnt lgkmcnt(0)
    v_cmp_ne_u32 vcc, 1, v3
    s_cmp_gt_u32 s14, 2000000
    s_cbranch_scc1 L_bse_17
    s_cbranch_vccnz L_bs_16
L_bse_17:
    ds_read_b64_tr_b16 v[136:137], v2 offset:0
    ds_read_b64_tr_b16 v[138:139], v2 offset:1024
    ds_read_b64_tr_b16 v[152:153], v2 offset:4096
    ds_read_b64_tr_b16 v[154:155], v2 offset:5120
    ds_read_b64_tr_b16 v[144:145], v2 offset:8
    ds_read_b64_tr_b16 v[146:147], v2 offset:1032
    ds_read_b64_tr_b16 v[160:161], v2 offset:4104
    ds_read_b64_tr_b16 v[162:163], v2 offset:5128
    ds_read_b64_tr_b16 v[140:141], v2 offset:2048
    ds_read_b64_tr_b16 v[142:143], v2 offset:3072
    ds_read_b64_tr_b16 v[156:157], v2 offset:6144
    ds_read_b64_tr_b16 v[158:159], v2 offset:7168
    ds_read_b64_tr_b16 v[148:149], v2 offset:2056
    ds_read_b64_tr_b16 v[150:151], v2 offset:3080
    ds_read_b64_tr_b16 v[164:165], v2 offset:6152
    s_waitcnt lgkmcnt(14)
    ds_read_b64_tr_b16 v[166:167], v2 offset:7176
    s_waitcnt lgkmcnt(14)
    v_mfma_f32_16x16x32_bf16 v[32:35], v[136:139], v[72:75], 0
    v_mfma_f32_16x16x32_bf16 v[40:43], v[136:139], v[88:91], 0
    s_waitcnt lgkmcnt(12)
    v_mfma_f32_16x16x32_bf16 v[32:35], v[152:155], v[80:83], v[32:35]
    v_mfma_f32_16x16x32_bf16 v[40:43], v[152:155], v[72:75], v[40:43]
    s_waitcnt lgkmcnt(10)
    v_mfma_f32_16x16x32_bf16 v[36:39], v[144:147], v[72:75], 0
    v_mfma_f32_16x16x32_bf16 v[44:47], v[144:147], v[88:91], 0
    s_waitcnt lgkmcnt(8)
    v_mfma_f32_16x16x32_bf16 v[36:39], v[160:163], v[80:83], v[36:39]
    v_mfma_f32_16x16x32_bf16 v[44:47], v[160:163], v[72:75], v[44:47]
    s_waitcnt lgkmcnt(6)
    v_mfma_f32_16x16x32_bf16 v[32:35], v[140:143], v[76:79], v[32:35]
    v_mfma_f32_16x16x32_bf16 v[40:43], v[140:143], v[92:95], v[40:43]
    s_waitcnt lgkmcnt(4)
    v_mfma_f32_16x16x32_bf16 v[32:35], v[156:159], v[84:87], v[32:35]
    v_mfma_f32_16x16x32_bf16 v[40:43], v[156:159], v[76:79], v[40:43]
    s_waitcnt lgkmcnt(2)
    v_mfma_f32_16x16x32_bf16 v[36:39], v[148:151], v[76:79], v[36:39]
    v_mfma_f32_16x16x32_bf16 v[44:47], v[148:151], v[92:95], v[44:47]
    s_waitcnt lgkmcnt(0)
    v_mfma_f32_16x16x32_bf16 v[36:39], v[164:167], v[84:87], v[36:39]
    v_mfma_f32_16x16x32_bf16 v[44:47], v[164:167], v[76:79], v[44:47]
    s_waitcnt vmcnt(0)
    ds_write_b32 v13, v10 offset:64
    v_pk_mul_f32 v[32:33], v[32:33], v[20:21]
    v_pk_mul_f32 v[34:35], v[34:35], v[22:23]
    s_nop 2
    v_pk_mul_f32 v[36:37], v[36:37], v[24:25]
    v_pk_mul_f32 v[38:39], v[38:39], v[26:27]
    v_cvt_pk_bf16_f32 v48, v32, v33
    v_cvt_pk_bf16_f32 v49, v34, v35
    v_cvt_pk_bf16_f32 v50, v36, v37
    v_cvt_pk_bf16_f32 v51, v38, v39
    buffer_store_dwordx4 v[48:51], v28, s[60:63], s16 offen offset:0 sc1
    v_pk_mul_f32 v[40:41], v[40:41], v[20:21]
    v_pk_mul_f32 v[42:43], v[42:43], v[22:23]
    v_pk_mul_f32 v[44:45], v[44:45], v[24:25]
    v_pk_mul_f32 v[46:47], v[46:47], v[26:27]
    v_cvt_pk_bf16_f32 v52, v40, v41
    v_cvt_pk_bf16_f32 v53, v42, v43
    v_cvt_pk_bf16_f32 v54, v44, v45
    v_cvt_pk_bf16_f32 v55, v46, v47
    buffer_store_dwordx4 v[52:55], v28, s[60:63], s16 offen offset:128 sc1
L_spb_10:
    s_lshl_b32 s15, s4, 8
    s_add_u32 s15, s15, s11
    s_lshl_b32 s15, s15, 4
    s_waitcnt vmcnt(0)
    v_cmp_eq_u32 vcc, 0, v1
    v_mov_b32 v30, 0x40000000
    v_mov_b32 v3, 12910592
    v_cndmask_b32 v30, v30, v3, vcc
    v_mov_b32 v3, s12
    buffer_store_dword v3, v30, s[60:63], s15 offen sc1
    s_lshr_b32 s15, s9, 3
    s_lshl2_add_u32 s15, s15, s4
    s_lshl_b32 s15, s15, 10
    s_add_u32 s15, s15, 12910592
    s_mov_b32 s75, s15
    v_bfe_u32 v3, v1, 4, 1
    v_lshlrev_b32 v3, 2, v3
    v_xor_b32 v11, v1, v3
    v_lshlrev_b32 v11, 4, v11
    s_lshl_b32 s74, s9, 16
    s_lshl_b32 s16, s4, 14
    s_add_u32 s74, s74, s16
    s_add_u32 s74, s74, 4194304
    v_bfe_u32 v4, v0, 3, 3
    v_and_b32 v3, 7, v0
    v_lshlrev_b32 v5, 1, v3
    v_xor_b32 v5, v5, v4
    v_lshlrev_b32 v5, 4, v5
    v_bfe_u32 v6, v0, 3, 4
    v_lshl_add_u32 v5, v6, 8, v5
    s_lshr_b32 s14, s4, 1
    s_lshl_b32 s14, s14, 14
    s_add_u32 s14, s14, 131072
    v_add_u32 v5, s14, v5
    v_xor_b32 v6, 16, v5
    v_and_b32 v7, 3, v4
    v_lshlrev_b32 v7, 2, v7
    v_bfe_u32 v9, v0, 5, 1
    v_lshl_add_u32 v7, v9, 10, v7
    v_lshlrev_b32 v4, 10, v4
    v_lshl_add_u32 v4, v3, 4, v4
    s_lshr_b32 s77, s9, 2
    s_lshl_b32 s77, s77, 18
    s_and_b32 s15, s9, 3
    s_lshl_b32 s15, s15, 13
    s_add_u32 s77, s77, s15
    s_lshl_b32 s15, s10, 7
    s_add_u32 s77, s77, s15
    s_add_u32 s16, s4, 4
    s_lshl_b32 s15, s16, 15
    s_add_u32 s77, s77, s15
    s_and_b32 s15, s9, 3
    s_bfe_u32 s17, s9, 0x10002
    s_lshl1_add_u32 s15, s15, s17
    s_lshl3_add_u32 s15, s15, s16
    s_lshr_b32 s17, s9, 3
    s_lshl_b32 s17, s17, 11
    s_lshl4_add_u32 s15, s15, s17
    s_add_u32 s15, s15, 12582912
    buffer_load_dword v8, v7, s[60:63], s15 offen sc1
    s_mov_b32 s15, s75
    ds_write_b32 v13, v10 offset:96
    s_mov_b32 s14, 0
L_bs_18:
    ds_read_b32 v3, v14 offset:96
    s_add_u32 s14, s14, 1
    s_waitcnt lgkmcnt(0)
    v_cmp_ne_u32 vcc, 1, v3
    s_cmp_gt_u32 s14, 2000000
    s_cbranch_scc1 L_bse_19
    s_cbranch_vccnz L_bs_18
L_bse_19:
    s_lshl2_add_u32 s14, s4, 8272
    v_mov_b32 v30, s14
    s_mov_b32 s14, 0
L_bs_20:
    s_sleep 4
    ds_read_b32 v3, v30
    s_add_u32 s14, s14, 1
    s_waitcnt lgkmcnt(0)
    v_cmp_ne_u32 vcc, 1, v3
    s_cmp_gt_u32 s14, 2000000
    s_cbranch_scc1 L_bse_21
    s_cbranch_vccnz L_bs_20
L_bse_21:
    v_lshlrev_b32 v30, 4, v1
    s_mov_b32 s14, 0
L_pi_22:
    buffer_load_dword v16, v30, s[60:63], s15 offen sc1
    s_add_u32 s14, s14, 1
    s_cmp_gt_u32 s14, 200000
    s_waitcnt vmcnt(0)
    v_cmp_ne_u32 vcc, s12, v16
    s_cbranch_scc1 L_pie_23
    s_and_b64 exec, vcc, vcc
    s_cbranch_scc1 L_pi_22
L_pie_23:
    s_mov_b64 exec, -1
    s_mov_b32 s15, s74
    s_and_b32 s18, s10, 1
    s_lshl_b32 s18, s18, 1
    s_add_u32 s16, s70, 98304
    s_xor_b32 s19, s18, 0
    s_lshl_b32 s20, s19, 14
    s_add_u32 m0, s16, s20
    s_lshl_b32 s19, s19, 12
    s_add_u32 s17, s15, s19
    buffer_load_dwordx4 v11, s[60:63], s17 offen offset:0 sc1 lds
    buffer_load_dwordx4 v11, s[60:63], s17 offen offset:1024 sc1 lds
    buffer_load_dwordx4 v11, s[60:63], s17 offen offset:2048 sc1 lds
    buffer_load_dwordx4 v11, s[60:63], s17 offen offset:3072 sc1 lds
    s_xor_b32 s19, s18, 2
    s_lshl_b32 s20, s19, 14
    s_add_u32 m0, s16, s20
    s_lshl_b32 s19, s19, 12
    s_add_u32 s17, s15, s19
    buffer_load_dwordx4 v11, s[60:63], s17 offen offset:0 sc1 lds
    buffer_load_dwordx4 v11, s[60:63], s17 offen offset:1024 sc1 lds
    buffer_load_dwordx4 v11, s[60:63], s17 offen offset:2048 sc1 lds
    buffer_load_dwordx4 v11, s[60:63], s17 offen offset:3072 sc1 lds
    s_xor_b32 s19, s18, 1
    s_lshl_b32 s20, s19, 14
    s_add_u32 m0, s16, s20
    s_lshl_b32 s19, s19, 12
    s_add_u32 s17, s15, s19
    buffer_load_dwordx4 v11, s[60:63], s17 offen offset:0 sc1 lds
    buffer_load_dwordx4 v11, s[60:63], s17 offen offset:1024 sc1 lds
    buffer_load_dwordx4 v11, s[60:63], s17 offen offset:2048 sc1 lds
    buffer_load_dwordx4 v11, s[60:63], s17 offen offset:3072 sc1 lds
    s_xor_b32 s19, s18, 3
    s_lshl_b32 s20, s19, 14
    s_add_u32 m0, s16, s20
    s_lshl_b32 s19, s19, 12
    s_add_u32 s17, s15, s19
    buffer_load_dwordx4 v11, s[60:63], s17 offen offset:0 sc1 lds
    buffer_load_dwordx4 v11, s[60:63], s17 offen offset:1024 sc1 lds
    buffer_load_dwordx4 v11, s[60:63], s17 offen offset:2048 sc1 lds
    buffer_load_dwordx4 v11, s[60:63], s17 offen offset:3072 sc1 lds
    s_waitcnt vmcnt(8)
    s_barrier
    s_waitcnt vmcnt(0)
    s_barrier
    s_cmp_eq_u32 s2, 0
    s_cselect_b32 s14, 13041664, 0x40000000
    v_cmp_eq_u32 vcc, 0, v0
    v_mov_b32 v30, 0x40000000
    v_mov_b32 v3, s14
    v_cndmask_b32 v30, v30, v3, vcc
    v_mov_b32 v3, s12
    buffer_store_dword v3, v30, s[60:63], 0 offen sc1
    v_add_f32 v8, 1.0, v8
    v_rcp_f32 v8, v8
    s_barrier
    ds_read_b128 v[32:35], v5 offset:0
    ds_read_b128 v[36:39], v6 offset:0
    ds_read_b128 v[40:43], v5 offset:4096
    ds_read_b128 v[44:47], v6 offset:4096
    ds_read_b128 v[48:51], v5 offset:8192
    ds_read_b128 v[52:55], v6 offset:8192
    ds_read_b128 v[56:59], v5 offset:12288
    ds_read_b128 v[60:63], v6 offset:12288
    s_waitcnt lgkmcnt(4)
    v_pk_add_f32 v[32:33], v[32:33], v[40:41]
    v_pk_add_f32 v[34:35], v[34:35], v[42:43]
    v_pk_add_f32 v[36:37], v[36:37], v[44:45]
    v_pk_add_f32 v[38:39], v[38:39], v[46:47]
    s_waitcnt lgkmcnt(0)
    v_pk_add_f32 v[48:49], v[48:49], v[56:57]
    v_pk_add_f32 v[50:51], v[50:51], v[58:59]
    v_pk_add_f32 v[52:53], v[52:53], v[60:61]
    v_pk_add_f32 v[54:55], v[54:55], v[62:63]
    v_pk_add_f32 v[32:33], v[32:33], v[48:49]
    v_pk_add_f32 v[34:35], v[34:35], v[50:51]
    v_pk_add_f32 v[36:37], v[36:37], v[52:53]
    v_pk_add_f32 v[38:39], v[38:39], v[54:55]
    v_pk_mul_f32 v[32:33], v[32:33], v[8:9] op_sel_hi:[1,0]
    v_pk_mul_f32 v[34:35], v[34:35], v[8:9] op_sel_hi:[1,0]
    v_pk_mul_f32 v[36:37], v[36:37], v[8:9] op_sel_hi:[1,0]
    v_pk_mul_f32 v[38:39], v[38:39], v[8:9] op_sel_hi:[1,0]
    v_cvt_pk_bf16_f32 v40, v32, v33
    v_cvt_pk_bf16_f32 v41, v34, v35
    v_cvt_pk_bf16_f32 v42, v36, v37
    v_cvt_pk_bf16_f32 v43, v38, v39
    buffer_store_dwordx4 v[40:43], v4, s[56:59], s77 offen sc1
    s_endpgm
L_roleA:
    s_mov_b32 s30, 2097152
    s_mov_b32 s31, 0x20000
    s_lshl_b32 s14, s4, 11
    s_add_u32 m0, s14, 147456
    s_lshl_b32 s16, s8, 13
    s_add_u32 s16, s16, s14
    s_and_b32 s14, s6, 7
    s_lshr_b32 s15, s6, 3
    s_add_u32 s79, s15, 5
    s_mul_i32 s15, s15, 21
    s_lshl1_add_u32 s7, s14, s79
    s_cmp_ge_u32 s14, s79
    s_cselect_b32 s79, 1, 0
    s_mul_i32 s14, s14, 3
    s_min_u32 s7, s7, s14
    s_add_u32 s7, s7, s15
    s_mov_b32 s46, 2752
    s_mov_b32 s47, 0x20000
    s_mov_b32 s62, 16777216
    s_mov_b32 s63, 0x20000
    v_and_b32 v30, 31, v1
    v_lshlrev_b32 v30, 1, v30
    s_lshl_b32 s14, s7, 6
    v_mov_b32 v31, 13041664
    s_waitcnt lgkmcnt(0)
    buffer_load_dwordx4 v2, s[28:31], s16 offen offset:0 lds
    buffer_load_dwordx4 v2, s[28:31], s16 offen offset:1024 lds
    s_mov_b32 s42, 1409024
    s_mov_b32 s43, 0x20000
    v_min_u32 v27, 10, v1
    v_lshlrev_b32 v27, 7, v27
    s_mul_i32 s26, s2, 5504
    s_mul_i32 s18, s4, 1408
    s_add_u32 s26, s26, s18
    buffer_load_dword v20, v27, s[40:43], s26 offen
    buffer_load_ushort v152, v30, s[44:47], s14 offen offset:0
    buffer_load_ushort v156, v30, s[44:47], s14 offen offset:64
    buffer_load_ushort v160, v30, s[44:47], s14 offen offset:128
    buffer_load_dword v29, v31, s[60:63], 0 offen sc1
    v_bfe_u32 v30, v1, 1, 3
    v_cvt_f32_u32 v58, v30
    s_lshl_b32 s14, s4, 3
    v_add_u32 v30, s14, v30
    v_cvt_f32_u32 v30, v30
    v_lshrrev_b32 v31, 2, v1
    v_and_b32 v31, 12, v31
    v_cvt_f32_u32 v31, v31
    v_and_b32 v3, 1, v1
    v_cvt_f32_u32 v3, v3
    v_mul_f32 v56, 0x3d000000, v30
    v_mul_f32 v59, 0x3e800000, v3
    v_fma_f32 v57, v56, v31, v59
    v_mov_b32 v48, v57
    v_add_f32 v49, v56, v57
    v_fmamk_f32 v50, v56, 0x40000000, v57
    v_fmamk_f32 v51, v56, 0x40400000, v57
    v_fmamk_f32 v52, v56, 0x41800000, v57
    v_fmamk_f32 v53, v56, 0x41880000, v57
    v_fmamk_f32 v54, v56, 0x41900000, v57
    v_fmamk_f32 v55, v56, 0x41980000, v57
    v_cos_f32 v48, v48
    v_cos_f32 v49, v49
    v_cos_f32 v50, v50
    v_cos_f32 v51, v51
    v_cos_f32 v52, v52
    v_cos_f32 v53, v53
    v_cos_f32 v54, v54
    v_cos_f32 v55, v55
    v_cvt_pk_bf16_f32 v32, v48, v49
    v_cvt_pk_bf16_f32 v33, v50, v51
    v_cvt_pk_bf16_f32 v34, v52, v53
    v_cvt_pk_bf16_f32 v35, v54, v55
    v_fma_f32 v47, v3, 2.0, -1.0
    v_mul_f32 v56, 0xbb000000, v30
    v_mul_f32 v56, v56, v47
    v_mul_f32 v57, v56, v31
    v_mov_b32 v48, v57
    v_add_f32 v49, v56, v57
    v_fmamk_f32 v50, v56, 0x40000000, v57
    v_fmamk_f32 v51, v56, 0x40400000, v57
    v_cos_f32 v36, v48
    v_sin_f32 v40, v48
    v_cos_f32 v37, v49
    v_sin_f32 v41, v49
    v_cos_f32 v38, v50
    v_sin_f32 v42, v50
    v_cos_f32 v39, v51
    v_sin_f32 v43, v51
    v_mul_f32 v56, 0x3d800000, v58
    v_and_b32 v30, 15, v1
    v_cmp_eq_u32 vcc, 1, v30
    v_cmp_gt_u32 s[20:21], 16, v1
    v_cmp_eq_u32 s[22:23], 1, v0
    v_cndmask_b32 v56, v56, 0.5, vcc
    v_cndmask_b32 v57, v59, 0, vcc
    v_fmac_f32 v57, v56, v31
    v_cndmask_b32 v46, v47, 0, s[20:21]
    v_cndmask_b32 v46, v46, 1.0, s[22:23]
    v_mov_b32 v48, v57
    v_add_f32 v49, v56, v57
    v_fmamk_f32 v50, v56, 0x40000000, v57
    v_fmamk_f32 v51, v56, 0x40400000, v57
    v_cos_f32 v48, v48
    v_cos_f32 v49, v49
    v_cos_f32 v50, v50
    v_cos_f32 v51, v51
    v_cvt_pk_bf16_f32 v44, v48, v49
    v_cvt_pk_bf16_f32 v45, v50, v51
    s_lshl_b32 s66, s4, 12
    v_and_b32 v30, 31, v1
    v_lshrrev_b32 v31, 5, v1
    v_bfe_u32 v3, v1, 1, 3
    v_xor_b32 v3, v3, v31
    v_lshlrev_b32 v3, 4, v3
    v_lshl_add_u32 v3, v30, 7, v3
    v_add_u32 v4, s66, v3
    v_xor_b32 v5, 32, v4
    v_xor_b32 v6, 64, v4
    v_xor_b32 v7, 96, v4
    v_bfe_u32 v30, v1, 2, 2
    v_lshl_add_u32 v30, v31, 3, v30
    v_mul_u32_u24 v30, 192, v30
    v_bfe_u32 v3, v1, 4, 1
    v_lshl_add_u32 v30, v3, 5, v30
    v_and_b32 v3, 3, v1
    v_lshl_add_u32 v30, v3, 3, v30
    v_add_u32 v8, 16384, v30
    v_add_u32 v9, 73728, v30
    s_lshl2_add_u32 s14, s5, s4
    s_mul_i32 s69, s14, 88064
    s_lshl_b32 s15, s7, 11
    s_add_u32 s69, s69, s15
    s_add_u32 s69, s69, 6291456
    v_cmp_gt_u32 vcc, 32, v1
    v_mov_b32 v30, 0x3f80
    v_mov_b32 v145, 0
    v_mov_b32 v146, 0
    v_mov_b32 v147, 0
    v_cndmask_b32 v144, 0, v30, vcc
    v_mov_b32 v153, 0
    v_mov_b32 v154, 0
    v_mov_b32 v155, 0
    v_mov_b32 v157, 0
    v_mov_b32 v158, 0
    v_mov_b32 v159, 0
    v_mov_b32 v161, 0
    v_mov_b32 v162, 0
    v_mov_b32 v163, 0
    v_lshlrev_b32 v22, 3, v1
    v_add_u32 v22, 147456, v22
    v_bfe_u32 v30, v1, 2, 2
    v_lshrrev_b32 v3, 4, v1
    v_lshl_add_u32 v30, v3, 5, v30
    v_lshlrev_b32 v30, 14, v30
    v_and_b32 v3, 3, v1
    v_lshl_add_u32 v23, v3, 4, v30
    s_lshl_b32 s14, s4, 16
    s_lshl_b32 s15, s8, 6
    s_add_u32 s14, s14, s15
    s_add_u32 s15, s14, 262144
    s_waitcnt vmcnt(5)
    s_barrier
    ds_read_b64_tr_b16 v[48:49], v22 offset:0
    ds_read_b64_tr_b16 v[50:51], v22 offset:512
    ds_read_b64_tr_b16 v[52:53], v22 offset:1024
    ds_read_b64_tr_b16 v[54:55], v22 offset:1536
    ds_read_b64_tr_b16 v[56:57], v22 offset:2048
    ds_read_b64_tr_b16 v[58:59], v22 offset:2560
    ds_read_b64_tr_b16 v[60:61], v22 offset:3072
    ds_read_b64_tr_b16 v[62:63], v22 offset:3584
    ds_read_b64_tr_b16 v[64:65], v22 offset:4096
    ds_read_b64_tr_b16 v[66:67], v22 offset:4608
    ds_read_b64_tr_b16 v[68:69], v22 offset:5120
    ds_read_b64_tr_b16 v[70:71], v22 offset:5632
    ds_read_b64_tr_b16 v[72:73], v22 offset:6144
    ds_read_b64_tr_b16 v[74:75], v22 offset:6656
    s_waitcnt lgkmcnt(12)
    v_mfma_f32_16x16x32_bf16 v[80:83], v[48:51], v[32:35], 0
    ds_read_b64_tr_b16 v[76:77], v22 offset:7168
    ds_read_b64_tr_b16 v[78:79], v22 offset:7680
    s_waitcnt lgkmcnt(12)
    v_mfma_f32_16x16x32_bf16 v[84:87], v[52:55], v[32:35], 0
    s_waitcnt lgkmcnt(10)
    v_mfma_f32_16x16x32_bf16 v[88:91], v[56:59], v[32:35], 0
    s_waitcnt lgkmcnt(8)
    v_mfma_f32_16x16x32_bf16 v[92:95], v[60:63], v[32:35], 0
    v_pk_mul_f32 v[48:49], v[80:81], v[36:37]
    v_pk_mul_f32 v[50:51], v[82:83], v[38:39]
    s_nop 0
    v_fmac_f32_dpp v48, v80, v40 quad_perm:[1,0,3,2] row_mask:0xf bank_mask:0xf
    v_fmac_f32_dpp v49, v81, v41 quad_perm:[1,0,3,2] row_mask:0xf bank_mask:0xf
    v_fmac_f32_dpp v50, v82, v42 quad_perm:[1,0,3,2] row_mask:0xf bank_mask:0xf
    v_fmac_f32_dpp v51, v83, v43 quad_perm:[1,0,3,2] row_mask:0xf bank_mask:0xf
    v_cvt_pk_bf16_f32 v80, v48, v49
    v_cvt_pk_bf16_f32 v81, v50, v51
    s_waitcnt lgkmcnt(6)
    v_mfma_f32_16x16x32_bf16 v[96:99], v[64:67], v[32:35], 0
    v_pk_mul_f32 v[52:53], v[84:85], v[36:37]
    v_pk_mul_f32 v[54:55], v[86:87], v[38:39]
    s_nop 0
    v_fmac_f32_dpp v52, v84, v40 quad_perm:[1,0,3,2] row_mask:0xf bank_mask:0xf
    v_fmac_f32_dpp v53, v85, v41 quad_perm:[1,0,3,2] row_mask:0xf bank_mask:0xf
    v_fmac_f32_dpp v54, v86, v42 quad_perm:[1,0,3,2] row_mask:0xf bank_mask:0xf
    v_fmac_f32_dpp v55, v87, v43 quad_perm:[1,0,3,2] row_mask:0xf bank_mask:0xf
    v_cvt_pk_bf16_f32 v84, v52, v53
    v_cvt_pk_bf16_f32 v85, v54, v55
    s_waitcnt lgkmcnt(4)
    v_mfma_f32_16x16x32_bf16 v[100:103], v[68:71], v[32:35], 0
    v_mfma_f32_16x16x16_bf16 v[48:51], v[44:45], v[80:81], 0
    v_pk_mul_f32 v[56:57], v[88:89], v[36:37]
    v_pk_mul_f32 v[58:59], v[90:91], v[38:39]
    s_nop 0
    v_fmac_f32_dpp v56, v88, v40 quad_perm:[1,0,3,2] row_mask:0xf bank_mask:0xf
    v_fmac_f32_dpp v57, v89, v41 quad_perm:[1,0,3,2] row_mask:0xf bank_mask:0xf
    v_fmac_f32_dpp v58, v90, v42 quad_perm:[1,0,3,2] row_mask:0xf bank_mask:0xf
    v_fmac_f32_dpp v59, v91, v43 quad_perm:[1,0,3,2] row_mask:0xf bank_mask:0xf
    v_cvt_pk_bf16_f32 v88, v56, v57
    v_cvt_pk_bf16_f32 v89, v58, v59
    s_waitcnt lgkmcnt(2)
    v_mfma_f32_16x16x32_bf16 v[104:107], v[72:75], v[32:35], 0
    v_mfma_f32_16x16x16_bf16 v[52:55], v[44:45], v[84:85], 0
    v_pk_mul_f32 v[60:61], v[92:93], v[36:37]
    v_pk_mul_f32 v[62:63], v[94:95], v[38:39]
    s_nop 0
    v_fmac_f32_dpp v60, v92, v40 quad_perm:[1,0,3,2] row_mask:0xf bank_mask:0xf
    v_fmac_f32_dpp v61, v93, v41 quad_perm:[1,0,3,2] row_mask:0xf bank_mask:0xf
    v_fmac_f32_dpp v62, v94, v42 quad_perm:[1,0,3,2] row_mask:0xf bank_mask:0xf
    v_fmac_f32_dpp v63, v95, v43 quad_perm:[1,0,3,2] row_mask:0xf bank_mask:0xf
    v_cvt_pk_bf16_f32 v92, v60, v61
    v_cvt_pk_bf16_f32 v93, v62, v63
    s_waitcnt lgkmcnt(0)
    v_mfma_f32_16x16x32_bf16 v[108:111], v[76:79], v[32:35], 0
    v_mfma_f32_16x16x16_bf16 v[56:59], v[44:45], v[88:89], 0
    v_fmac_f32_dpp v48, v49, v46 quad_perm:[1,0,3,2] row_mask:0xf bank_mask:0xf
    v_fmac_f32_dpp v50, v51, v47 quad_perm:[1,0,3,2] row_mask:0xf bank_mask:0xf
    v_pk_mul_f32 v[64:65], v[96:97], v[36:37]
    v_pk_mul_f32 v[66:67], v[98:99], v[38:39]
    s_nop 0
    v_fmac_f32_dpp v64, v96, v40 quad_perm:[1,0,3,2] row_mask:0xf bank_mask:0xf
    v_fmac_f32_dpp v65, v97, v41 quad_perm:[1,0,3,2] row_mask:0xf bank_mask:0xf
    v_fmac_f32_dpp v66, v98, v42 quad_perm:[1,0,3,2] row_mask:0xf bank_mask:0xf
    v_fmac_f32_dpp v67, v99, v43 quad_perm:[1,0,3,2] row_mask:0xf bank_mask:0xf
    v_cvt_pk_bf16_f32 v96, v64, v65
    v_cvt_pk_bf16_f32 v97, v66, v67
    v_mfma_f32_16x16x16_bf16 v[60:63], v[44:45], v[92:93], 0
    v_fmac_f32_dpp v52, v53, v46 quad_perm:[1,0,3,2] row_mask:0xf bank_mask:0xf
    v_fmac_f32_dpp v54, v55, v47 quad_perm:[1,0,3,2] row_mask:0xf bank_mask:0xf
    v_pk_mul_f32 v[68:69], v[100:101], v[36:37]
    v_pk_mul_f32 v[70:71], v[102:103], v[38:39]
    s_nop 0
    v_fmac_f32_dpp v68, v100, v40 quad_perm:[1,0,3,2] row_mask:0xf bank_mask:0xf
    v_fmac_f32_dpp v69, v101, v41 quad_perm:[1,0,3,2] row_mask:0xf bank_mask:0xf
    v_fmac_f32_dpp v70, v102, v42 quad_perm:[1,0,3,2] row_mask:0xf bank_mask:0xf
    v_fmac_f32_dpp v71, v103, v43 quad_perm:[1,0,3,2] row_mask:0xf bank_mask:0xf
    v_cvt_pk_bf16_f32 v100, v68, v69
    v_cvt_pk_bf16_f32 v101, v70, v71
    v_mfma_f32_16x16x16_bf16 v[64:67], v[44:45], v[96:97], 0
    v_fmac_f32_dpp v56, v57, v46 quad_perm:[1,0,3,2] row_mask:0xf bank_mask:0xf
    v_fmac_f32_dpp v58, v59, v47 quad_perm:[1,0,3,2] row_mask:0xf bank_mask:0xf
    v_pk_mul_f32 v[72:73], v[104:105], v[36:37]
    v_pk_mul_f32 v[74:75], v[106:107], v[38:39]
    s_nop 0
    v_fmac_f32_dpp v72, v104, v40 quad_perm:[1,0,3,2] row_mask:0xf bank_mask:0xf
    v_fmac_f32_dpp v73, v105, v41 quad_perm:[1,0,3,2] row_mask:0xf bank_mask:0xf
    v_fmac_f32_dpp v74, v106, v42 quad_perm:[1,0,3,2] row_mask:0xf bank_mask:0xf
    v_fmac_f32_dpp v75, v107, v43 quad_perm:[1,0,3,2] row_mask:0xf bank_mask:0xf
    v_cvt_pk_bf16_f32 v104, v72, v73
    v_cvt_pk_bf16_f32 v105, v74, v75
    v_mfma_f32_16x16x16_bf16 v[68:71], v[44:45], v[100:101], 0
    v_fmac_f32_dpp v60, v61, v46 quad_perm:[1,0,3,2] row_mask:0xf bank_mask:0xf
    v_fmac_f32_dpp v62, v63, v47 quad_perm:[1,0,3,2] row_mask:0xf bank_mask:0xf
    v_pk_mul_f32 v[76:77], v[108:109], v[36:37]
    v_pk_mul_f32 v[78:79], v[110:111], v[38:39]
    s_nop 0
    v_fmac_f32_dpp v76, v108, v40 quad_perm:[1,0,3,2] row_mask:0xf bank_mask:0xf
    v_fmac_f32_dpp v77, v109, v41 quad_perm:[1,0,3,2] row_mask:0xf bank_mask:0xf
    v_fmac_f32_dpp v78, v110, v42 quad_perm:[1,0,3,2] row_mask:0xf bank_mask:0xf
    v_fmac_f32_dpp v79, v111, v43 quad_perm:[1,0,3,2] row_mask:0xf bank_mask:0xf
    v_cvt_pk_bf16_f32 v108, v76, v77
    v_cvt_pk_bf16_f32 v109, v78, v79
    v_mfma_f32_16x16x16_bf16 v[72:75], v[44:45], v[104:105], 0
    v_fmac_f32_dpp v64, v65, v46 quad_perm:[1,0,3,2] row_mask:0xf bank_mask:0xf
    v_fmac_f32_dpp v66, v67, v47 quad_perm:[1,0,3,2] row_mask:0xf bank_mask:0xf
    v_mfma_f32_16x16x16_bf16 v[76:79], v[44:45], v[108:109], 0
    v_fmac_f32_dpp v68, v69, v46 quad_perm:[1,0,3,2] row_mask:0xf bank_mask:0xf
    v_fmac_f32_dpp v70, v71, v47 quad_perm:[1,0,3,2] row_mask:0xf bank_mask:0xf
    s_nop 2
    v_fmac_f32_dpp v72, v73, v46 quad_perm:[1,0,3,2] row_mask:0xf bank_mask:0xf
    v_fmac_f32_dpp v74, v75, v47 quad_perm:[1,0,3,2] row_mask:0xf bank_mask:0xf
    s_nop 0
    v_fmac_f32_dpp v76, v77, v46 quad_perm:[1,0,3,2] row_mask:0xf bank_mask:0xf
    v_fmac_f32_dpp v78, v79, v47 quad_perm:[1,0,3,2] row_mask:0xf bank_mask:0xf
    v_cvt_pk_bf16_f32 v80, v48, v52
    v_cvt_pk_bf16_f32 v81, v56, v60
    v_cvt_pk_bf16_f32 v82, v64, v68
    v_cvt_pk_bf16_f32 v83, v72, v76
    buffer_store_dwordx4 v[80:83], v23, s[60:63], s14 offen sc1
    v_cvt_pk_bf16_f32 v84, v50, v54
    v_cvt_pk_bf16_f32 v85, v58, v62
    v_cvt_pk_bf16_f32 v86, v66, v70
    v_cvt_pk_bf16_f32 v87, v74, v78
    buffer_store_dwordx4 v[84:87], v23, s[60:63], s15 offen sc1
    s_mov_b32 s50, 1409024
    s_mov_b32 s51, 0x20000
    s_mov_b32 s58, 2097152
    s_mov_b32 s59, 0x20000
    s_waitcnt vmcnt(2)
    v_readfirstlane_b32 s12, v29
    s_nop 0
    s_add_u32 s12, s12, 4
    s_mov_b32 s14, s9
    s_and_b32 s14, s14, 7
    s_mul_i32 s14, s14, 5
    s_add_u32 s14, s14, s4
    v_lshl_add_u32 v30, v1, 2, s14
    v_subrev_u32 v3, 43, v30
    v_min_u32 v30, v30, v3
    s_lshl_b32 s14, s10, 7
    s_lshl_b32 s70, s4, 12
    v_cmp_eq_u32 vcc, 202, v0
    v_mov_b32 v31, 0x4000
    s_mul_i32 s15, s9, 176128
    v_cndmask_b32 v30, v30, v31, vcc
    s_add_u32 s15, s15, 6291456
    v_lshl_add_u32 v21, v30, 11, s15
    v_lshl_add_u32 v20, v30, 15, s14
    v_lshrrev_b32 v30, 3, v1
    v_lshlrev_b32 v30, 10, v30
    v_and_b32 v3, 7, v1
    v_lshrrev_b32 v31, 2, v1
    v_and_b32 v31, 4, v31
    v_xor_b32 v3, v3, v31
    v_lshl_add_u32 v25, v3, 4, v30
    v_add_u32 v27, 7168, v25
    v_add_u32 v29, 14336, v25
    v_add_u32 v28, 21504, v25
    v_bfe_u32 v23, v1, 4, 1
    v_lshrrev_b32 v31, 5, v1
    v_bfe_u32 v30, v1, 2, 2
    v_lshl_add_u32 v3, v31, 2, v30
    v_lshlrev_b32 v3, 7, v3
    v_bfe_u32 v26, v1, 3, 1
    v_lshl_add_u32 v3, v26, 6, v3
    v_lshl_add_u32 v3, v23, 5, v3
    v_and_b32 v24, 3, v1
    v_lshl_add_u32 v3, v24, 3, v3
    v_add_u32 v14, s70, v3
    v_xor_b32 v15, 64, v14
    v_add_u32 v10, 65536, v14
    v_add_u32 v11, 65536, v15
    v_add_u32 v12, 131072, v14
    v_add_u32 v13, 131072, v15
    v_mul_u32_u24 v31, 32256, v31
    v_add_u32 v31, 98304, v31
    v_add_u32 v16, v14, v31
    v_xor_b32 v17, 64, v16
    v_mov_b32 v31, v28
    s_lshl_b32 s14, s10, 6
    v_and_or_b32 v30, v1, 31, s14
    s_lshl_b32 s14, s4, 6
    v_and_or_b32 v23, v1, 32, s14
    v_cvt_f32_u32 v23, v23
    s_mov_b32 s72, 0x36000000
    s_mov_b32 s73, 0xb6000000
    v_add_u32 v3, 0, v30
    v_cvt_f32_u32 v119, v3
    v_mul_f32 v119, 0x3b000000, v119
    v_mul_f32 v112, v119, v23
    v_add_f32 v114, v119, v112
    v_fract_f32 v112, v112
    v_fract_f32 v114, v114
    v_cos_f32 v118, v119
    v_sin_f32 v113, v112
    v_sin_f32 v115, v114
    v_cos_f32 v112, v112
    v_cos_f32 v114, v114
    v_add_f32 v118, v118, v118
    v_pk_mul_f32 v[112:113], v[112:113], s[72:73]
    v_pk_mul_f32 v[114:115], v[114:115], s[72:73]
    v_add_u32 v3, 32, v30
    v_cvt_f32_u32 v127, v3
    v_mul_f32 v127, 0x3b000000, v127
    v_mul_f32 v120, v127, v23
    v_add_f32 v122, v127, v120
    v_fract_f32 v120, v120
    v_fract_f32 v122, v122
    v_cos_f32 v126, v127
    v_sin_f32 v121, v120
    v_sin_f32 v123, v122
    v_cos_f32 v120, v120
    v_cos_f32 v122, v122
    v_add_f32 v126, v126, v126
    v_pk_mul_f32 v[120:121], v[120:121], s[72:73]
    v_pk_mul_f32 v[122:123], v[122:123], s[72:73]
    v_cvt_pk_bf16_f32 v32, v112, v113
    v_cvt_pk_bf16_f32 v36, v120, v121
    v_cvt_pk_bf16_f32 v33, v114, v115
    v_cvt_pk_bf16_f32 v37, v122, v123
    v_pk_fma_f32 v[116:117], v[114:115], v[118:119], v[112:113] op_sel_hi:[1,0,1] neg_lo:[0,0,1] neg_hi:[0,0,1]
    v_pk_fma_f32 v[124:125], v[122:123], v[126:127], v[120:121] op_sel_hi:[1,0,1] neg_lo:[0,0,1] neg_hi:[0,0,1]
    v_cvt_pk_bf16_f32 v34, v116, v117
    v_cvt_pk_bf16_f32 v38, v124, v125
    v_pk_fma_f32 v[112:113], v[116:117], v[118:119], v[114:115] op_sel_hi:[1,0,1] neg_lo:[0,0,1] neg_hi:[0,0,1]
    v_pk_fma_f32 v[120:121], v[124:125], v[126:127], v[122:123] op_sel_hi:[1,0,1] neg_lo:[0,0,1] neg_hi:[0,0,1]
    v_cvt_pk_bf16_f32 v35, v112, v113
    v_cvt_pk_bf16_f32 v39, v120, v121
    v_pk_fma_f32 v[114:115], v[112:113], v[118:119], v[116:117] op_sel_hi:[1,0,1] neg_lo:[0,0,1] neg_hi:[0,0,1]
    v_pk_fma_f32 v[122:123], v[120:121], v[126:127], v[124:125] op_sel_hi:[1,0,1] neg_lo:[0,0,1] neg_hi:[0,0,1]
    v_cvt_pk_bf16_f32 v40, v114, v115
    v_cvt_pk_bf16_f32 v44, v122, v123
    v_pk_fma_f32 v[116:117], v[114:115], v[118:119], v[112:113] op_sel_hi:[1,0,1] neg_lo:[0,0,1] neg_hi:[0,0,1]
    v_pk_fma_f32 v[124:125], v[122:123], v[126:127], v[120:121] op_sel_hi:[1,0,1] neg_lo:[0,0,1] neg_hi:[0,0,1]
    v_cvt_pk_bf16_f32 v41, v116, v117
    v_cvt_pk_bf16_f32 v45, v124, v125
    v_pk_fma_f32 v[112:113], v[116:117], v[118:119], v[114:115] op_sel_hi:[1,0,1] neg_lo:[0,0,1] neg_hi:[0,0,1]
    v_pk_fma_f32 v[120:121], v[124:125], v[126:127], v[122:123] op_sel_hi:[1,0,1] neg_lo:[0,0,1] neg_hi:[0,0,1]
    v_cvt_pk_bf16_f32 v42, v112, v113
    v_cvt_pk_bf16_f32 v46, v120, v121
    v_pk_fma_f32 v[114:115], v[112:113], v[118:119], v[116:117] op_sel_hi:[1,0,1] neg_lo:[0,0,1] neg_hi:[0,0,1]
    v_pk_fma_f32 v[122:123], v[120:121], v[126:127], v[124:125] op_sel_hi:[1,0,1] neg_lo:[0,0,1] neg_hi:[0,0,1]
    v_cvt_pk_bf16_f32 v43, v114, v115
    v_cvt_pk_bf16_f32 v47, v122, v123
    v_pk_fma_f32 v[116:117], v[114:115], v[118:119], v[112:113] op_sel_hi:[1,0,1] neg_lo:[0,0,1] neg_hi:[0,0,1]
    v_pk_fma_f32 v[124:125], v[122:123], v[126:127], v[120:121] op_sel_hi:[1,0,1] neg_lo:[0,0,1] neg_hi:[0,0,1]
    v_cvt_pk_bf16_f32 v48, v116, v117
    v_cvt_pk_bf16_f32 v52, v124, v125
    v_pk_fma_f32 v[112:113], v[116:117], v[118:119], v[114:115] op_sel_hi:[1,0,1] neg_lo:[0,0,1] neg_hi:[0,0,1]
    v_pk_fma_f32 v[120:121], v[124:125], v[126:127], v[122:123] op_sel_hi:[1,0,1] neg_lo:[0,0,1] neg_hi:[0,0,1]
    v_cvt_pk_bf16_f32 v49, v112, v113
    v_cvt_pk_bf16_f32 v53, v120, v121
    v_pk_fma_f32 v[114:115], v[112:113], v[118:119], v[116:117] op_sel_hi:[1,0,1] neg_lo:[0,0,1] neg_hi:[0,0,1]
    v_pk_fma_f32 v[122:123], v[120:121], v[126:127], v[124:125] op_sel_hi:[1,0,1] neg_lo:[0,0,1] neg_hi:[0,0,1]
    v_cvt_pk_bf16_f32 v50, v114, v115
    v_cvt_pk_bf16_f32 v54, v122, v123
    v_pk_fma_f32 v[116:117], v[114:115], v[118:119], v[112:113] op_sel_hi:[1,0,1] neg_lo:[0,0,1] neg_hi:[0,0,1]
    v_pk_fma_f32 v[124:125], v[122:123], v[126:127], v[120:121] op_sel_hi:[1,0,1] neg_lo:[0,0,1] neg_hi:[0,0,1]
    v_cvt_pk_bf16_f32 v51, v116, v117
    v_cvt_pk_bf16_f32 v55, v124, v125
    v_pk_fma_f32 v[112:113], v[116:117], v[118:119], v[114:115] op_sel_hi:[1,0,1] neg_lo:[0,0,1] neg_hi:[0,0,1]
    v_pk_fma_f32 v[120:121], v[124:125], v[126:127], v[122:123] op_sel_hi:[1,0,1] neg_lo:[0,0,1] neg_hi:[0,0,1]
    v_cvt_pk_bf16_f32 v56, v112, v113
    v_cvt_pk_bf16_f32 v60, v120, v121
    v_pk_fma_f32 v[114:115], v[112:113], v[118:119], v[116:117] op_sel_hi:[1,0,1] neg_lo:[0,0,1] neg_hi:[0,0,1]
    v_pk_fma_f32 v[122:123], v[120:121], v[126:127], v[124:125] op_sel_hi:[1,0,1] neg_lo:[0,0,1] neg_hi:[0,0,1]
    v_cvt_pk_bf16_f32 v57, v114, v115
    v_cvt_pk_bf16_f32 v61, v122, v123
    v_pk_fma_f32 v[116:117], v[114:115], v[118:119], v[112:113] op_sel_hi:[1,0,1] neg_lo:[0,0,1] neg_hi:[0,0,1]
    v_pk_fma_f32 v[124:125], v[122:123], v[126:127], v[120:121] op_sel_hi:[1,0,1] neg_lo:[0,0,1] neg_hi:[0,0,1]
    v_cvt_pk_bf16_f32 v58, v116, v117
    v_cvt_pk_bf16_f32 v62, v124, v125
    v_pk_fma_f32 v[112:113], v[116:117], v[118:119], v[114:115] op_sel_hi:[1,0,1] neg_lo:[0,0,1] neg_hi:[0,0,1]
    v_pk_fma_f32 v[120:121], v[124:125], v[126:127], v[122:123] op_sel_hi:[1,0,1] neg_lo:[0,0,1] neg_hi:[0,0,1]
    v_cvt_pk_bf16_f32 v59, v112, v113
    v_cvt_pk_bf16_f32 v63, v120, v121
    v_pk_fma_f32 v[114:115], v[112:113], v[118:119], v[116:117] op_sel_hi:[1,0,1] neg_lo:[0,0,1] neg_hi:[0,0,1]
    v_pk_fma_f32 v[122:123], v[120:121], v[126:127], v[124:125] op_sel_hi:[1,0,1] neg_lo:[0,0,1] neg_hi:[0,0,1]
    v_cvt_pk_bf16_f32 v64, v114, v115
    v_cvt_pk_bf16_f32 v68, v122, v123
    v_pk_fma_f32 v[116:117], v[114:115], v[118:119], v[112:113] op_sel_hi:[1,0,1] neg_lo:[0,0,1] neg_hi:[0,0,1]
    v_pk_fma_f32 v[124:125], v[122:123], v[126:127], v[120:121] op_sel_hi:[1,0,1] neg_lo:[0,0,1] neg_hi:[0,0,1]
    v_cvt_pk_bf16_f32 v65, v116, v117
    v_cvt_pk_bf16_f32 v69, v124, v125
    v_pk_fma_f32 v[112:113], v[116:117], v[118:119], v[114:115] op_sel_hi:[1,0,1] neg_lo:[0,0,1] neg_hi:[0,0,1]
    v_pk_fma_f32 v[120:121], v[124:125], v[126:127], v[122:123] op_sel_hi:[1,0,1] neg_lo:[0,0,1] neg_hi:[0,0,1]
    v_cvt_pk_bf16_f32 v66, v112, v113
    v_cvt_pk_bf16_f32 v70, v120, v121
    v_pk_fma_f32 v[114:115], v[112:113], v[118:119], v[116:117] op_sel_hi:[1,0,1] neg_lo:[0,0,1] neg_hi:[0,0,1]
    v_pk_fma_f32 v[122:123], v[120:121], v[126:127], v[124:125] op_sel_hi:[1,0,1] neg_lo:[0,0,1] neg_hi:[0,0,1]
    v_cvt_pk_bf16_f32 v67, v114, v115
    v_cvt_pk_bf16_f32 v71, v122, v123
    v_pk_fma_f32 v[116:117], v[114:115], v[118:119], v[112:113] op_sel_hi:[1,0,1] neg_lo:[0,0,1] neg_hi:[0,0,1]
    v_pk_fma_f32 v[124:125], v[122:123], v[126:127], v[120:121] op_sel_hi:[1,0,1] neg_lo:[0,0,1] neg_hi:[0,0,1]
    v_cvt_pk_bf16_f32 v72, v116, v117
    v_cvt_pk_bf16_f32 v76, v124, v125
    v_pk_fma_f32 v[112:113], v[116:117], v[118:119], v[114:115] op_sel_hi:[1,0,1] neg_lo:[0,0,1] neg_hi:[0,0,1]
    v_pk_fma_f32 v[120:121], v[124:125], v[126:127], v[122:123] op_sel_hi:[1,0,1] neg_lo:[0,0,1] neg_hi:[0,0,1]
    v_cvt_pk_bf16_f32 v73, v112, v113
    v_cvt_pk_bf16_f32 v77, v120, v121
    v_pk_fma_f32 v[114:115], v[112:113], v[118:119], v[116:117] op_sel_hi:[1,0,1] neg_lo:[0,0,1] neg_hi:[0,0,1]
    v_pk_fma_f32 v[122:123], v[120:121], v[126:127], v[124:125] op_sel_hi:[1,0,1] neg_lo:[0,0,1] neg_hi:[0,0,1]
    v_cvt_pk_bf16_f32 v74, v114, v115
    v_cvt_pk_bf16_f32 v78, v122, v123
    v_pk_fma_f32 v[116:117], v[114:115], v[118:119], v[112:113] op_sel_hi:[1,0,1] neg_lo:[0,0,1] neg_hi:[0,0,1]
    v_pk_fma_f32 v[124:125], v[122:123], v[126:127], v[120:121] op_sel_hi:[1,0,1] neg_lo:[0,0,1] neg_hi:[0,0,1]
    v_cvt_pk_bf16_f32 v75, v116, v117
    v_cvt_pk_bf16_f32 v79, v124, v125
    v_pk_fma_f32 v[112:113], v[116:117], v[118:119], v[114:115] op_sel_hi:[1,0,1] neg_lo:[0,0,1] neg_hi:[0,0,1]
    v_pk_fma_f32 v[120:121], v[124:125], v[126:127], v[122:123] op_sel_hi:[1,0,1] neg_lo:[0,0,1] neg_hi:[0,0,1]
    v_cvt_pk_bf16_f32 v80, v112, v113
    v_cvt_pk_bf16_f32 v84, v120, v121
    v_pk_fma_f32 v[114:115], v[112:113], v[118:119], v[116:117] op_sel_hi:[1,0,1] neg_lo:[0,0,1] neg_hi:[0,0,1]
    v_pk_fma_f32 v[122:123], v[120:121], v[126:127], v[124:125] op_sel_hi:[1,0,1] neg_lo:[0,0,1] neg_hi:[0,0,1]
    v_cvt_pk_bf16_f32 v81, v114, v115
    v_cvt_pk_bf16_f32 v85, v122, v123
    v_pk_fma_f32 v[116:117], v[114:115], v[118:119], v[112:113] op_sel_hi:[1,0,1] neg_lo:[0,0,1] neg_hi:[0,0,1]
    v_pk_fma_f32 v[124:125], v[122:123], v[126:127], v[120:121] op_sel_hi:[1,0,1] neg_lo:[0,0,1] neg_hi:[0,0,1]
    v_cvt_pk_bf16_f32 v82, v116, v117
    v_cvt_pk_bf16_f32 v86, v124, v125
    v_pk_fma_f32 v[112:113], v[116:117], v[118:119], v[114:115] op_sel_hi:[1,0,1] neg_lo:[0,0,1] neg_hi:[0,0,1]
    v_pk_fma_f32 v[120:121], v[124:125], v[126:127], v[122:123] op_sel_hi:[1,0,1] neg_lo:[0,0,1] neg_hi:[0,0,1]
    v_cvt_pk_bf16_f32 v83, v112, v113
    v_cvt_pk_bf16_f32 v87, v120, v121
    v_pk_fma_f32 v[114:115], v[112:113], v[118:119], v[116:117] op_sel_hi:[1,0,1] neg_lo:[0,0,1] neg_hi:[0,0,1]
    v_pk_fma_f32 v[122:123], v[120:121], v[126:127], v[124:125] op_sel_hi:[1,0,1] neg_lo:[0,0,1] neg_hi:[0,0,1]
    v_cvt_pk_bf16_f32 v88, v114, v115
    v_cvt_pk_bf16_f32 v92, v122, v123
    v_pk_fma_f32 v[116:117], v[114:115], v[118:119], v[112:113] op_sel_hi:[1,0,1] neg_lo:[0,0,1] neg_hi:[0,0,1]
    v_pk_fma_f32 v[124:125], v[122:123], v[126:127], v[120:121] op_sel_hi:[1,0,1] neg_lo:[0,0,1] neg_hi:[0,0,1]
    v_cvt_pk_bf16_f32 v89, v116, v117
    v_cvt_pk_bf16_f32 v93, v124, v125
    v_pk_fma_f32 v[112:113], v[116:117], v[118:119], v[114:115] op_sel_hi:[1,0,1] neg_lo:[0,0,1] neg_hi:[0,0,1]
    v_pk_fma_f32 v[120:121], v[124:125], v[126:127], v[122:123] op_sel_hi:[1,0,1] neg_lo:[0,0,1] neg_hi:[0,0,1]
    v_cvt_pk_bf16_f32 v90, v112, v113
    v_cvt_pk_bf16_f32 v94, v120, v121
    v_pk_fma_f32 v[114:115], v[112:113], v[118:119], v[116:117] op_sel_hi:[1,0,1] neg_lo:[0,0,1] neg_hi:[0,0,1]
    v_pk_fma_f32 v[122:123], v[120:121], v[126:127], v[124:125] op_sel_hi:[1,0,1] neg_lo:[0,0,1] neg_hi:[0,0,1]
    v_cvt_pk_bf16_f32 v91, v114, v115
    v_cvt_pk_bf16_f32 v95, v122, v123
    v_lshlrev_b32 v3, 31, v1
    v_or_b32 v3, 0x35803580, v3
    v_cmp_gt_u32 vcc, 32, v0
    s_nop 1
    v_cndmask_b32 v32, v32, v3, vcc
    v_cndmask_b32 v36, v36, v3, vcc
    v_mfma_f32_32x32x16_bf16 v[96:111], v[152:155], v[144:147], 0
    v_mfma_f32_32x32x16_bf16 v[112:127], v[156:159], v[144:147], 0
    v_mfma_f32_32x32x16_bf16 v[128:143], v[160:163], v[144:147], 0
    s_barrier
    ds_read_b128 v[144:147], v4 offset:0
    ds_read_b64_tr_b16 v[152:153], v8 offset:0
    ds_read_b64_tr_b16 v[154:155], v8 offset:768
    ds_read_b64_tr_b16 v[156:157], v8 offset:64
    ds_read_b64_tr_b16 v[158:159], v8 offset:832
    ds_read_b64_tr_b16 v[160:161], v8 offset:128
    ds_read_b64_tr_b16 v[162:163], v8 offset:896
    s_waitcnt lgkmcnt(4)
    v_mfma_f32_32x32x16_bf16 v[96:111], v[152:155], v[144:147], v[96:111]
    ds_read_b128 v[148:151], v5 offset:0
    ds_read_b64_tr_b16 v[164:165], v8 offset:3072
    ds_read_b64_tr_b16 v[166:167], v8 offset:3840
    s_waitcnt lgkmcnt(5)
    v_mfma_f32_32x32x16_bf16 v[112:127], v[156:159], v[144:147], v[112:127]
    ds_read_b64_tr_b16 v[168:169], v8 offset:3136
    ds_read_b64_tr_b16 v[170:171], v8 offset:3904
    s_waitcnt lgkmcnt(5)
    v_mfma_f32_32x32x16_bf16 v[128:143], v[160:163], v[144:147], v[128:143]
    ds_read_b64_tr_b16 v[172:173], v8 offset:3200
    ds_read_b64_tr_b16 v[174:175], v8 offset:3968
    s_waitcnt lgkmcnt(4)
    v_mfma_f32_32x32x16_bf16 v[96:111], v[164:167], v[148:151], v[96:111]
    ds_read_b128 v[144:147], v6 offset:0
    ds_read_b64_tr_b16 v[152:153], v8 offset:6144
    ds_read_b64_tr_b16 v[154:155], v8 offset:6912
    s_waitcnt lgkmcnt(5)
    v_mfma_f32_32x32x16_bf16 v[112:127], v[168:171], v[148:151], v[112:127]
    ds_read_b64_tr_b16 v[156:157], v8 offset:6208
    ds_read_b64_tr_b16 v[158:159], v8 offset:6976
    s_waitcnt lgkmcnt(5)
    v_mfma_f32_32x32x16_bf16 v[128:143], v[172:175], v[148:151], v[128:143]
    ds_read_b64_tr_b16 v[160:161], v8 offset:6272
    ds_read_b64_tr_b16 v[162:163], v8 offset:7040
    s_waitcnt lgkmcnt(4)
    v_mfma_f32_32x32x16_bf16 v[96:111], v[152:155], v[144:147], v[96:111]
    ds_read_b128 v[148:151], v7 offset:0
    ds_read_b64_tr_b16 v[164:165], v8 offset:9216
    ds_read_b64_tr_b16 v[166:167], v8 offset:9984
    s_waitcnt lgkmcnt(5)
    v_mfma_f32_32x32x16_bf16 v[112:127], v[156:159], v[144:147], v[112:127]
    ds_read_b64_tr_b16 v[168:169], v8 offset:9280
    ds_read_b64_tr_b16 v[170:171], v8 offset:10048
    s_waitcnt lgkmcnt(5)
    v_mfma_f32_32x32x16_bf16 v[128:143], v[160:163], v[144:147], v[128:143]
    ds_read_b64_tr_b16 v[172:173], v8 offset:9344
    ds_read_b64_tr_b16 v[174:175], v8 offset:10112
    s_waitcnt lgkmcnt(4)
    v_mfma_f32_32x32x16_bf16 v[96:111], v[164:167], v[148:151], v[96:111]
    s_barrier
    ds_read_b128 v[144:147], v4 offset:28672
    ds_read_b64_tr_b16 v[152:153], v8 offset:28672
    ds_read_b64_tr_b16 v[154:155], v8 offset:29440
    s_waitcnt lgkmcnt(5)
    v_mfma_f32_32x32x16_bf16 v[112:127], v[168:171], v[148:151], v[112:127]
    ds_read_b64_tr_b16 v[156:157], v8 offset:28736
    ds_read_b64_tr_b16 v[158:159], v8 offset:29504
    s_waitcnt lgkmcnt(5)
    v_mfma_f32_32x32x16_bf16 v[128:143], v[172:175], v[148:151], v[128:143]
    ds_read_b64_tr_b16 v[160:161], v8 offset:28800
    ds_read_b64_tr_b16 v[162:163], v8 offset:29568
    s_waitcnt lgkmcnt(4)
    v_mfma_f32_32x32x16_bf16 v[96:111], v[152:155], v[144:147], v[96:111]
    ds_read_b128 v[148:151], v5 offset:28672
    ds_read_b64_tr_b16 v[164:165], v8 offset:31744
    ds_read_b64_tr_b16 v[166:167], v8 offset:32512
    s_waitcnt lgkmcnt(5)
    v_mfma_f32_32x32x16_bf16 v[112:127], v[156:159], v[144:147], v[112:127]
    ds_read_b64_tr_b16 v[168:169], v8 offset:31808
    ds_read_b64_tr_b16 v[170:171], v8 offset:32576
    s_waitcnt lgkmcnt(5)
    v_mfma_f32_32x32x16_bf16 v[128:143], v[160:163], v[144:147], v[128:143]
    ds_read_b64_tr_b16 v[172:173], v8 offset:31872
    ds_read_b64_tr_b16 v[174:175], v8 offset:32640
    s_waitcnt lgkmcnt(4)
    v_mfma_f32_32x32x16_bf16 v[96:111], v[164:167], v[148:151], v[96:111]
    ds_read_b128 v[144:147], v6 offset:28672
    ds_read_b64_tr_b16 v[152:153], v8 offset:34816
    ds_read_b64_tr_b16 v[154:155], v8 offset:35584
    s_waitcnt lgkmcnt(5)
    v_mfma_f32_32x32x16_bf16 v[112:127], v[168:171], v[148:151], v[112:127]
    ds_read_b64_tr_b16 v[156:157], v8 offset:34880
    ds_read_b64_tr_b16 v[158:159], v8 offset:35648
    s_waitcnt lgkmcnt(5)
    v_mfma_f32_32x32x16_bf16 v[128:143], v[172:175], v[148:151], v[128:143]
    ds_read_b64_tr_b16 v[160:161], v8 offset:34944
    ds_read_b64_tr_b16 v[162:163], v8 offset:35712
    s_waitcnt lgkmcnt(4)
    v_mfma_f32_32x32x16_bf16 v[96:111], v[152:155], v[144:147], v[96:111]
    ds_read_b128 v[148:151], v7 offset:28672
    ds_read_b64_tr_b16 v[164:165], v8 offset:37888
    ds_read_b64_tr_b16 v[166:167], v8 offset:38656
    s_waitcnt lgkmcnt(5)
    v_mfma_f32_32x32x16_bf16 v[112:127], v[156:159], v[144:147], v[112:127]
    ds_read_b64_tr_b16 v[168:169], v8 offset:37952
    ds_read_b64_tr_b16 v[170:171], v8 offset:38720
    s_waitcnt lgkmcnt(5)
    v_mfma_f32_32x32x16_bf16 v[128:143], v[160:163], v[144:147], v[128:143]
    ds_read_b64_tr_b16 v[172:173], v8 offset:38016
    ds_read_b64_tr_b16 v[174:175], v8 offset:38784
    s_waitcnt lgkmcnt(4)
    v_mfma_f32_32x32x16_bf16 v[96:111], v[164:167], v[148:151], v[96:111]
    s_waitcnt vmcnt(0)
    s_barrier
    ds_read_b128 v[144:147], v4 offset:57344
    ds_read_b64_tr_b16 v[152:153], v9 offset:0
    ds_read_b64_tr_b16 v[154:155], v9 offset:768
    s_waitcnt lgkmcnt(5)
    v_mfma_f32_32x32x16_bf16 v[112:127], v[168:171], v[148:151], v[112:127]
    ds_read_b64_tr_b16 v[156:157], v9 offset:64
    ds_read_b64_tr_b16 v[158:159], v9 offset:832
    s_waitcnt lgkmcnt(5)
    v_mfma_f32_32x32x16_bf16 v[128:143], v[172:175], v[148:151], v[128:143]
    ds_read_b64_tr_b16 v[160:161], v9 offset:128
    ds_read_b64_tr_b16 v[162:163], v9 offset:896
    s_waitcnt lgkmcnt(4)
    v_mfma_f32_32x32x16_bf16 v[96:111], v[152:155], v[144:147], v[96:111]
    ds_read_b128 v[148:151], v5 offset:57344
    ds_read_b64_tr_b16 v[164:165], v9 offset:3072
    ds_read_b64_tr_b16 v[166:167], v9 offset:3840
    s_waitcnt lgkmcnt(5)
    v_mfma_f32_32x32x16_bf16 v[112:127], v[156:159], v[144:147], v[112:127]
    ds_read_b64_tr_b16 v[168:169], v9 offset:3136
    ds_read_b64_tr_b16 v[170:171], v9 offset:3904
    s_waitcnt lgkmcnt(5)
    v_mfma_f32_32x32x16_bf16 v[128:143], v[160:163], v[144:147], v[128:143]
    ds_read_b64_tr_b16 v[172:173], v9 offset:3200
    ds_read_b64_tr_b16 v[174:175], v9 offset:3968
    s_waitcnt lgkmcnt(4)
    v_mfma_f32_32x32x16_bf16 v[96:111], v[164:167], v[148:151], v[96:111]
    ds_read_b128 v[144:147], v6 offset:57344
    ds_read_b64_tr_b16 v[152:153], v9 offset:6144
    ds_read_b64_tr_b16 v[154:155], v9 offset:6912
    s_waitcnt lgkmcnt(5)
    v_mfma_f32_32x32x16_bf16 v[112:127], v[168:171], v[148:151], v[112:127]
    ds_read_b64_tr_b16 v[156:157], v9 offset:6208
    ds_read_b64_tr_b16 v[158:159], v9 offset:6976
    s_waitcnt lgkmcnt(5)
    v_mfma_f32_32x32x16_bf16 v[128:143], v[172:175], v[148:151], v[128:143]
    ds_read_b64_tr_b16 v[160:161], v9 offset:6272
    ds_read_b64_tr_b16 v[162:163], v9 offset:7040
    s_waitcnt lgkmcnt(4)
    v_mfma_f32_32x32x16_bf16 v[96:111], v[152:155], v[144:147], v[96:111]
    ds_read_b128 v[148:151], v7 offset:57344
    ds_read_b64_tr_b16 v[164:165], v9 offset:9216
    ds_read_b64_tr_b16 v[166:167], v9 offset:9984
    s_waitcnt lgkmcnt(5)
    v_mfma_f32_32x32x16_bf16 v[112:127], v[156:159], v[144:147], v[112:127]
    ds_read_b64_tr_b16 v[168:169], v9 offset:9280
    ds_read_b64_tr_b16 v[170:171], v9 offset:10048
    s_waitcnt lgkmcnt(5)
    v_mfma_f32_32x32x16_bf16 v[128:143], v[160:163], v[144:147], v[128:143]
    ds_read_b64_tr_b16 v[172:173], v9 offset:9344
    ds_read_b64_tr_b16 v[174:175], v9 offset:10112
    s_waitcnt lgkmcnt(4)
    v_mfma_f32_32x32x16_bf16 v[96:111], v[164:167], v[148:151], v[96:111]
    s_barrier
    v_add_u32 v30, 86016, v4
    ds_read_b128 v[144:147], v30
    ds_read_b64_tr_b16 v[152:153], v9 offset:28672
    ds_read_b64_tr_b16 v[154:155], v9 offset:29440
    s_waitcnt lgkmcnt(5)
    v_mfma_f32_32x32x16_bf16 v[112:127], v[168:171], v[148:151], v[112:127]
    ds_read_b64_tr_b16 v[156:157], v9 offset:28736
    ds_read_b64_tr_b16 v[158:159], v9 offset:29504
    s_waitcnt lgkmcnt(5)
    v_mfma_f32_32x32x16_bf16 v[128:143], v[172:175], v[148:151], v[128:143]
    ds_read_b64_tr_b16 v[160:161], v9 offset:28800
    ds_read_b64_tr_b16 v[162:163], v9 offset:29568
    s_waitcnt lgkmcnt(4)
    v_mfma_f32_32x32x16_bf16 v[96:111], v[152:155], v[144:147], v[96:111]
    v_add_u32 v30, 86016, v5
    ds_read_b128 v[148:151], v30
    ds_read_b64_tr_b16 v[164:165], v9 offset:31744
    ds_read_b64_tr_b16 v[166:167], v9 offset:32512
    s_waitcnt lgkmcnt(5)
    v_mfma_f32_32x32x16_bf16 v[112:127], v[156:159], v[144:147], v[112:127]
    ds_read_b64_tr_b16 v[168:169], v9 offset:31808
    ds_read_b64_tr_b16 v[170:171], v9 offset:32576
    s_waitcnt lgkmcnt(5)
    v_mfma_f32_32x32x16_bf16 v[128:143], v[160:163], v[144:147], v[128:143]
    ds_read_b64_tr_b16 v[172:173], v9 offset:31872
    ds_read_b64_tr_b16 v[174:175], v9 offset:32640
    s_waitcnt lgkmcnt(4)
    v_mfma_f32_32x32x16_bf16 v[96:111], v[164:167], v[148:151], v[96:111]
    v_add_u32 v30, 86016, v6
    ds_read_b128 v[144:147], v30
    ds_read_b64_tr_b16 v[152:153], v9 offset:34816
    ds_read_b64_tr_b16 v[154:155], v9 offset:35584
    s_waitcnt lgkmcnt(5)
    v_mfma_f32_32x32x16_bf16 v[112:127], v[168:171], v[148:151], v[112:127]
    ds_read_b64_tr_b16 v[156:157], v9 offset:34880
    ds_read_b64_tr_b16 v[158:159], v9 offset:35648
    s_waitcnt lgkmcnt(5)
    v_mfma_f32_32x32x16_bf16 v[128:143], v[172:175], v[148:151], v[128:143]
    ds_read_b64_tr_b16 v[160:161], v9 offset:34944
    ds_read_b64_tr_b16 v[162:163], v9 offset:35712
    s_waitcnt lgkmcnt(4)
    v_mfma_f32_32x32x16_bf16 v[96:111], v[152:155], v[144:147], v[96:111]
    v_add_u32 v30, 86016, v7
    ds_read_b128 v[148:151], v30
    ds_read_b64_tr_b16 v[164:165], v9 offset:37888
    ds_read_b64_tr_b16 v[166:167], v9 offset:38656
    s_waitcnt lgkmcnt(5)
    v_mfma_f32_32x32x16_bf16 v[112:127], v[156:159], v[144:147], v[112:127]
    ds_read_b64_tr_b16 v[168:169], v9 offset:37952
    ds_read_b64_tr_b16 v[170:171], v9 offset:38720
    s_waitcnt lgkmcnt(5)
    v_mfma_f32_32x32x16_bf16 v[128:143], v[160:163], v[144:147], v[128:143]
    ds_read_b64_tr_b16 v[172:173], v9 offset:38016
    ds_read_b64_tr_b16 v[174:175], v9 offset:38784
    s_waitcnt lgkmcnt(4)
    v_mfma_f32_32x32x16_bf16 v[96:111], v[164:167], v[148:151], v[96:111]
    s_barrier
    ds_read_b128 v[144:147], v4 offset:0
    ds_read_b64_tr_b16 v[152:153], v8 offset:0
    ds_read_b64_tr_b16 v[154:155], v8 offset:768
    s_waitcnt lgkmcnt(5)
    v_mfma_f32_32x32x16_bf16 v[112:127], v[168:171], v[148:151], v[112:127]
    ds_read_b64_tr_b16 v[156:157], v8 offset:64
    ds_read_b64_tr_b16 v[158:159], v8 offset:832
    s_waitcnt lgkmcnt(5)
    v_mfma_f32_32x32x16_bf16 v[128:143], v[172:175], v[148:151], v[128:143]
    ds_read_b64_tr_b16 v[160:161], v8 offset:128
    ds_read_b64_tr_b16 v[162:163], v8 offset:896
    s_waitcnt lgkmcnt(4)
    v_mfma_f32_32x32x16_bf16 v[96:111], v[152:155], v[144:147], v[96:111]
    ds_read_b128 v[148:151], v5 offset:0
    ds_read_b64_tr_b16 v[164:165], v8 offset:3072
    ds_read_b64_tr_b16 v[166:167], v8 offset:3840
    s_waitcnt lgkmcnt(5)
    v_mfma_f32_32x32x16_bf16 v[112:127], v[156:159], v[144:147], v[112:127]
    ds_read_b64_tr_b16 v[168:169], v8 offset:3136
    ds_read_b64_tr_b16 v[170:171], v8 offset:3904
    s_waitcnt lgkmcnt(5)
    v_mfma_f32_32x32x16_bf16 v[128:143], v[160:163], v[144:147], v[128:143]
    ds_read_b64_tr_b16 v[172:173], v8 offset:3200
    ds_read_b64_tr_b16 v[174:175], v8 offset:3968
    s_waitcnt lgkmcnt(4)
    v_mfma_f32_32x32x16_bf16 v[96:111], v[164:167], v[148:151], v[96:111]
    ds_read_b128 v[144:147], v6 offset:0
    ds_read_b64_tr_b16 v[152:153], v8 offset:6144
    ds_read_b64_tr_b16 v[154:155], v8 offset:6912
    s_waitcnt lgkmcnt(5)
    v_mfma_f32_32x32x16_bf16 v[112:127], v[168:171], v[148:151], v[112:127]
    ds_read_b64_tr_b16 v[156:157], v8 offset:6208
    ds_read_b64_tr_b16 v[158:159], v8 offset:6976
    s_waitcnt lgkmcnt(5)
    v_mfma_f32_32x32x16_bf16 v[128:143], v[172:175], v[148:151], v[128:143]
    ds_read_b64_tr_b16 v[160:161], v8 offset:6272
    ds_read_b64_tr_b16 v[162:163], v8 offset:7040
    s_waitcnt lgkmcnt(4)
    v_mfma_f32_32x32x16_bf16 v[96:111], v[152:155], v[144:147], v[96:111]
    ds_read_b128 v[148:151], v7 offset:0
    ds_read_b64_tr_b16 v[164:165], v8 offset:9216
    ds_read_b64_tr_b16 v[166:167], v8 offset:9984
    s_waitcnt lgkmcnt(5)
    v_mfma_f32_32x32x16_bf16 v[112:127], v[156:159], v[144:147], v[112:127]
    ds_read_b64_tr_b16 v[168:169], v8 offset:9280
    ds_read_b64_tr_b16 v[170:171], v8 offset:10048
    s_waitcnt lgkmcnt(5)
    v_mfma_f32_32x32x16_bf16 v[128:143], v[160:163], v[144:147], v[128:143]
    ds_read_b64_tr_b16 v[172:173], v8 offset:9344
    ds_read_b64_tr_b16 v[174:175], v8 offset:10112
    s_waitcnt lgkmcnt(4)
    v_mfma_f32_32x32x16_bf16 v[96:111], v[164:167], v[148:151], v[96:111]
    s_barrier
    ds_read_b128 v[144:147], v4 offset:28672
    ds_read_b64_tr_b16 v[152:153], v8 offset:28672
    ds_read_b64_tr_b16 v[154:155], v8 offset:29440
    s_waitcnt lgkmcnt(5)
    v_mfma_f32_32x32x16_bf16 v[112:127], v[168:171], v[148:151], v[112:127]
    ds_read_b64_tr_b16 v[156:157], v8 offset:28736
    ds_read_b64_tr_b16 v[158:159], v8 offset:29504
    s_waitcnt lgkmcnt(5)
    v_mfma_f32_32x32x16_bf16 v[128:143], v[172:175], v[148:151], v[128:143]
    ds_read_b64_tr_b16 v[160:161], v8 offset:28800
    ds_read_b64_tr_b16 v[162:163], v8 offset:29568
    s_waitcnt lgkmcnt(4)
    v_mfma_f32_32x32x16_bf16 v[96:111], v[152:155], v[144:147], v[96:111]
    ds_read_b128 v[148:151], v5 offset:28672
    ds_read_b64_tr_b16 v[164:165], v8 offset:31744
    ds_read_b64_tr_b16 v[166:167], v8 offset:32512
    s_waitcnt lgkmcnt(5)
    v_mfma_f32_32x32x16_bf16 v[112:127], v[156:159], v[144:147], v[112:127]
    ds_read_b64_tr_b16 v[168:169], v8 offset:31808
    ds_read_b64_tr_b16 v[170:171], v8 offset:32576
    s_waitcnt lgkmcnt(5)
    v_mfma_f32_32x32x16_bf16 v[128:143], v[160:163], v[144:147], v[128:143]
    ds_read_b64_tr_b16 v[172:173], v8 offset:31872
    ds_read_b64_tr_b16 v[174:175], v8 offset:32640
    s_waitcnt lgkmcnt(4)
    v_mfma_f32_32x32x16_bf16 v[96:111], v[164:167], v[148:151], v[96:111]
    ds_read_b128 v[144:147], v6 offset:28672
    ds_read_b64_tr_b16 v[152:153], v8 offset:34816
    ds_read_b64_tr_b16 v[154:155], v8 offset:35584
    s_waitcnt lgkmcnt(5)
    v_mfma_f32_32x32x16_bf16 v[112:127], v[168:171], v[148:151], v[112:127]
    ds_read_b64_tr_b16 v[156:157], v8 offset:34880
    ds_read_b64_tr_b16 v[158:159], v8 offset:35648
    s_waitcnt lgkmcnt(5)
    v_mfma_f32_32x32x16_bf16 v[128:143], v[172:175], v[148:151], v[128:143]
    ds_read_b64_tr_b16 v[160:161], v8 offset:34944
    ds_read_b64_tr_b16 v[162:163], v8 offset:35712
    s_waitcnt lgkmcnt(4)
    v_mfma_f32_32x32x16_bf16 v[96:111], v[152:155], v[144:147], v[96:111]
    ds_read_b128 v[148:151], v7 offset:28672
    ds_read_b64_tr_b16 v[164:165], v8 offset:37888
    ds_read_b64_tr_b16 v[166:167], v8 offset:38656
    s_waitcnt lgkmcnt(5)
    v_mfma_f32_32x32x16_bf16 v[112:127], v[156:159], v[144:147], v[112:127]
    ds_read_b64_tr_b16 v[168:169], v8 offset:37952
    ds_read_b64_tr_b16 v[170:171], v8 offset:38720
    s_waitcnt lgkmcnt(5)
    v_mfma_f32_32x32x16_bf16 v[128:143], v[160:163], v[144:147], v[128:143]
    ds_read_b64_tr_b16 v[172:173], v8 offset:38016
    ds_read_b64_tr_b16 v[174:175], v8 offset:38784
    s_waitcnt lgkmcnt(4)
    v_mfma_f32_32x32x16_bf16 v[96:111], v[164:167], v[148:151], v[96:111]
    s_barrier
    ds_read_b128 v[144:147], v4 offset:57344
    ds_read_b64_tr_b16 v[152:153], v9 offset:0
    ds_read_b64_tr_b16 v[154:155], v9 offset:768
    s_waitcnt lgkmcnt(5)
    v_mfma_f32_32x32x16_bf16 v[112:127], v[168:171], v[148:151], v[112:127]
    ds_read_b64_tr_b16 v[156:157], v9 offset:64
    ds_read_b64_tr_b16 v[158:159], v9 offset:832
    s_waitcnt lgkmcnt(5)
    v_mfma_f32_32x32x16_bf16 v[128:143], v[172:175], v[148:151], v[128:143]
    ds_read_b64_tr_b16 v[160:161], v9 offset:128
    ds_read_b64_tr_b16 v[162:163], v9 offset:896
    s_waitcnt lgkmcnt(4)
    v_mfma_f32_32x32x16_bf16 v[96:111], v[152:155], v[144:147], v[96:111]
    ds_read_b128 v[148:151], v5 offset:57344
    ds_read_b64_tr_b16 v[164:165], v9 offset:3072
    ds_read_b64_tr_b16 v[166:167], v9 offset:3840
    s_waitcnt lgkmcnt(5)
    v_mfma_f32_32x32x16_bf16 v[112:127], v[156:159], v[144:147], v[112:127]
    ds_read_b64_tr_b16 v[168:169], v9 offset:3136
    ds_read_b64_tr_b16 v[170:171], v9 offset:3904
    s_waitcnt lgkmcnt(5)
    v_mfma_f32_32x32x16_bf16 v[128:143], v[160:163], v[144:147], v[128:143]
    ds_read_b64_tr_b16 v[172:173], v9 offset:3200
    ds_read_b64_tr_b16 v[174:175], v9 offset:3968
    s_waitcnt lgkmcnt(4)
    v_mfma_f32_32x32x16_bf16 v[96:111], v[164:167], v[148:151], v[96:111]
    ds_read_b128 v[144:147], v6 offset:57344
    ds_read_b64_tr_b16 v[152:153], v9 offset:6144
    ds_read_b64_tr_b16 v[154:155], v9 offset:6912
    s_waitcnt lgkmcnt(5)
    v_mfma_f32_32x32x16_bf16 v[112:127], v[168:171], v[148:151], v[112:127]
    ds_read_b64_tr_b16 v[156:157], v9 offset:6208
    ds_read_b64_tr_b16 v[158:159], v9 offset:6976
    s_waitcnt lgkmcnt(5)
    v_mfma_f32_32x32x16_bf16 v[128:143], v[172:175], v[148:151], v[128:143]
    ds_read_b64_tr_b16 v[160:161], v9 offset:6272
    ds_read_b64_tr_b16 v[162:163], v9 offset:7040
    s_waitcnt lgkmcnt(4)
    v_mfma_f32_32x32x16_bf16 v[96:111], v[152:155], v[144:147], v[96:111]
    ds_read_b128 v[148:151], v7 offset:57344
    ds_read_b64_tr_b16 v[164:165], v9 offset:9216
    ds_read_b64_tr_b16 v[166:167], v9 offset:9984
    s_waitcnt lgkmcnt(5)
    v_mfma_f32_32x32x16_bf16 v[112:127], v[156:159], v[144:147], v[112:127]
    ds_read_b64_tr_b16 v[168:169], v9 offset:9280
    ds_read_b64_tr_b16 v[170:171], v9 offset:10048
    s_waitcnt lgkmcnt(5)
    v_mfma_f32_32x32x16_bf16 v[128:143], v[160:163], v[144:147], v[128:143]
    ds_read_b64_tr_b16 v[172:173], v9 offset:9344
    ds_read_b64_tr_b16 v[174:175], v9 offset:10112
    s_waitcnt lgkmcnt(4)
    v_mfma_f32_32x32x16_bf16 v[96:111], v[164:167], v[148:151], v[96:111]
    s_barrier
    v_add_u32 v30, 86016, v4
    ds_read_b128 v[144:147], v30
    ds_read_b64_tr_b16 v[152:153], v9 offset:28672
    ds_read_b64_tr_b16 v[154:155], v9 offset:29440
    s_waitcnt lgkmcnt(5)
    v_mfma_f32_32x32x16_bf16 v[112:127], v[168:171], v[148:151], v[112:127]
    ds_read_b64_tr_b16 v[156:157], v9 offset:28736
    ds_read_b64_tr_b16 v[158:159], v9 offset:29504
    s_waitcnt lgkmcnt(5)
    v_mfma_f32_32x32x16_bf16 v[128:143], v[172:175], v[148:151], v[128:143]
    ds_read_b64_tr_b16 v[160:161], v9 offset:28800
    ds_read_b64_tr_b16 v[162:163], v9 offset:29568
    s_waitcnt lgkmcnt(4)
    v_mfma_f32_32x32x16_bf16 v[96:111], v[152:155], v[144:147], v[96:111]
    v_add_u32 v30, 86016, v5
    ds_read_b128 v[148:151], v30
    ds_read_b64_tr_b16 v[164:165], v9 offset:31744
    ds_read_b64_tr_b16 v[166:167], v9 offset:32512
    s_waitcnt lgkmcnt(5)
    v_mfma_f32_32x32x16_bf16 v[112:127], v[156:159], v[144:147], v[112:127]
    ds_read_b64_tr_b16 v[168:169], v9 offset:31808
    ds_read_b64_tr_b16 v[170:171], v9 offset:32576
    s_waitcnt lgkmcnt(5)
    v_mfma_f32_32x32x16_bf16 v[128:143], v[160:163], v[144:147], v[128:143]
    ds_read_b64_tr_b16 v[172:173], v9 offset:31872
    ds_read_b64_tr_b16 v[174:175], v9 offset:32640
    s_waitcnt lgkmcnt(4)
    v_mfma_f32_32x32x16_bf16 v[96:111], v[164:167], v[148:151], v[96:111]
    v_add_u32 v30, 86016, v6
    ds_read_b128 v[144:147], v30
    ds_read_b64_tr_b16 v[152:153], v9 offset:34816
    ds_read_b64_tr_b16 v[154:155], v9 offset:35584
    s_waitcnt lgkmcnt(5)
    v_mfma_f32_32x32x16_bf16 v[112:127], v[168:171], v[148:151], v[112:127]
    ds_read_b64_tr_b16 v[156:157], v9 offset:34880
    ds_read_b64_tr_b16 v[158:159], v9 offset:35648
    s_waitcnt lgkmcnt(5)
    v_mfma_f32_32x32x16_bf16 v[128:143], v[172:175], v[148:151], v[128:143]
    ds_read_b64_tr_b16 v[160:161], v9 offset:34944
    ds_read_b64_tr_b16 v[162:163], v9 offset:35712
    s_waitcnt lgkmcnt(4)
    v_mfma_f32_32x32x16_bf16 v[96:111], v[152:155], v[144:147], v[96:111]
    v_add_u32 v30, 86016, v7
    ds_read_b128 v[148:151], v30
    ds_read_b64_tr_b16 v[164:165], v9 offset:37888
    ds_read_b64_tr_b16 v[166:167], v9 offset:38656
    s_waitcnt lgkmcnt(5)
    v_mfma_f32_32x32x16_bf16 v[112:127], v[156:159], v[144:147], v[112:127]
    ds_read_b64_tr_b16 v[168:169], v9 offset:37952
    ds_read_b64_tr_b16 v[170:171], v9 offset:38720
    s_waitcnt lgkmcnt(5)
    v_mfma_f32_32x32x16_bf16 v[128:143], v[160:163], v[144:147], v[128:143]
    ds_read_b64_tr_b16 v[172:173], v9 offset:38016
    ds_read_b64_tr_b16 v[174:175], v9 offset:38784
    s_waitcnt lgkmcnt(4)
    v_mfma_f32_32x32x16_bf16 v[96:111], v[164:167], v[148:151], v[96:111]
    s_waitcnt lgkmcnt(2)
    v_mfma_f32_32x32x16_bf16 v[112:127], v[168:171], v[148:151], v[112:127]
    s_waitcnt lgkmcnt(0)
    v_mfma_f32_32x32x16_bf16 v[128:143], v[172:175], v[148:151], v[128:143]
    s_barrier
    s_setprio 2
    s_cmp_eq_u32 s79, 1
    s_cselect_b32 s16, 0x40000000, 0
    s_add_u32 s17, s69, s16
    s_add_u32 s17, s17, 4096
    s_mov_b32 s72, 0x3fb8aa3b
    s_nop 0
    v_pk_mul_f32 v[144:145], v[96:97], s[72:73] op_sel_hi:[1,0]
    v_pk_mul_f32 v[146:147], v[98:99], s[72:73] op_sel_hi:[1,0]
    v_pk_mul_f32 v[148:149], v[100:101], s[72:73] op_sel_hi:[1,0]
    v_pk_mul_f32 v[150:151], v[102:103], s[72:73] op_sel_hi:[1,0]
    v_exp_f32 v144, v144
    v_exp_f32 v145, v145
    v_exp_f32 v146, v146
    v_exp_f32 v147, v147
    v_exp_f32 v148, v148
    v_exp_f32 v149, v149
    v_exp_f32 v150, v150
    v_exp_f32 v151, v151
    v_pk_fma_f32 v[152:153], v[144:145], 0.5, 1.0 op_sel_hi:[1,0,0]
    v_pk_fma_f32 v[154:155], v[146:147], 0.5, 1.0 op_sel_hi:[1,0,0]
    v_pk_fma_f32 v[156:157], v[148:149], 0.5, 1.0 op_sel_hi:[1,0,0]
    v_pk_fma_f32 v[158:159], v[150:151], 0.5, 1.0 op_sel_hi:[1,0,0]
    v_pk_fma_f32 v[144:145], v[144:145], v[152:153], 1.0 op_sel_hi:[1,1,0]
    v_pk_fma_f32 v[146:147], v[146:147], v[154:155], 1.0 op_sel_hi:[1,1,0]
    v_pk_fma_f32 v[148:149], v[148:149], v[156:157], 1.0 op_sel_hi:[1,1,0]
    v_pk_fma_f32 v[150:151], v[150:151], v[158:159], 1.0 op_sel_hi:[1,1,0]
    v_rcp_f32 v144, v144
    v_rcp_f32 v145, v145
    v_rcp_f32 v146, v146
    v_rcp_f32 v147, v147
    v_rcp_f32 v148, v148
    v_rcp_f32 v149, v149
    v_rcp_f32 v150, v150
    v_rcp_f32 v151, v151
    v_pk_fma_f32 v[144:145], v[96:97], v[144:145], v[96:97] neg_lo:[1,0,0] neg_hi:[1,0,0]
    v_pk_fma_f32 v[146:147], v[98:99], v[146:147], v[98:99] neg_lo:[1,0,0] neg_hi:[1,0,0]
    v_pk_fma_f32 v[148:149], v[100:101], v[148:149], v[100:101] neg_lo:[1,0,0] neg_hi:[1,0,0]
    v_pk_fma_f32 v[150:151], v[102:103], v[150:151], v[102:103] neg_lo:[1,0,0] neg_hi:[1,0,0]
    v_cvt_pk_bf16_f32 v160, v144, v145
    v_cvt_pk_bf16_f32 v161, v146, v147
    v_cvt_pk_bf16_f32 v162, v148, v149
    v_cvt_pk_bf16_f32 v163, v150, v151
    buffer_store_dwordx4 v[160:163], v2, s[60:63], s69 offen offset:0 sc1
    v_pk_mul_f32 v[144:145], v[104:105], s[72:73] op_sel_hi:[1,0]
    v_pk_mul_f32 v[146:147], v[106:107], s[72:73] op_sel_hi:[1,0]
    v_pk_mul_f32 v[148:149], v[108:109], s[72:73] op_sel_hi:[1,0]
    v_pk_mul_f32 v[150:151], v[110:111], s[72:73] op_sel_hi:[1,0]
    v_exp_f32 v144, v144
    v_exp_f32 v145, v145
    v_exp_f32 v146, v146
    v_exp_f32 v147, v147
    v_exp_f32 v148, v148
    v_exp_f32 v149, v149
    v_exp_f32 v150, v150
    v_exp_f32 v151, v151
    v_pk_fma_f32 v[152:153], v[144:145], 0.5, 1.0 op_sel_hi:[1,0,0]
    v_pk_fma_f32 v[154:155], v[146:147], 0.5, 1.0 op_sel_hi:[1,0,0]
    v_pk_fma_f32 v[156:157], v[148:149], 0.5, 1.0 op_sel_hi:[1,0,0]
    v_pk_fma_f32 v[158:159], v[150:151], 0.5, 1.0 op_sel_hi:[1,0,0]
    v_pk_fma_f32 v[144:145], v[144:145], v[152:153], 1.0 op_sel_hi:[1,1,0]
    v_pk_fma_f32 v[146:147], v[146:147], v[154:155], 1.0 op_sel_hi:[1,1,0]
    v_pk_fma_f32 v[148:149], v[148:149], v[156:157], 1.0 op_sel_hi:[1,1,0]
    v_pk_fma_f32 v[150:151], v[150:151], v[158:159], 1.0 op_sel_hi:[1,1,0]
    v_rcp_f32 v144, v144
    v_rcp_f32 v145, v145
    v_rcp_f32 v146, v146
    v_rcp_f32 v147, v147
    v_rcp_f32 v148, v148
    v_rcp_f32 v149, v149
    v_rcp_f32 v150, v150
    v_rcp_f32 v151, v151
    v_pk_fma_f32 v[144:145], v[104:105], v[144:145], v[104:105] neg_lo:[1,0,0] neg_hi:[1,0,0]
    v_pk_fma_f32 v[146:147], v[106:107], v[146:147], v[106:107] neg_lo:[1,0,0] neg_hi:[1,0,0]
    v_pk_fma_f32 v[148:149], v[108:109], v[148:149], v[108:109] neg_lo:[1,0,0] neg_hi:[1,0,0]
    v_pk_fma_f32 v[150:151], v[110:111], v[150:151], v[110:111] neg_lo:[1,0,0] neg_hi:[1,0,0]
    v_cvt_pk_bf16_f32 v164, v144, v145
    v_cvt_pk_bf16_f32 v165, v146, v147
    v_cvt_pk_bf16_f32 v166, v148, v149
    v_cvt_pk_bf16_f32 v167, v150, v151
    buffer_store_dwordx4 v[164:167], v2, s[60:63], s69 offen offset:1024 sc1
    v_pk_mul_f32 v[144:145], v[112:113], s[72:73] op_sel_hi:[1,0]
    v_pk_mul_f32 v[146:147], v[114:115], s[72:73] op_sel_hi:[1,0]
    v_pk_mul_f32 v[148:149], v[116:117], s[72:73] op_sel_hi:[1,0]
    v_pk_mul_f32 v[150:151], v[118:119], s[72:73] op_sel_hi:[1,0]
    v_exp_f32 v144, v144
    v_exp_f32 v145, v145
    v_exp_f32 v146, v146
    v_exp_f32 v147, v147
    v_exp_f32 v148, v148
    v_exp_f32 v149, v149
    v_exp_f32 v150, v150
    v_exp_f32 v151, v151
    v_pk_fma_f32 v[152:153], v[144:145], 0.5, 1.0 op_sel_hi:[1,0,0]
    v_pk_fma_f32 v[154:155], v[146:147], 0.5, 1.0 op_sel_hi:[1,0,0]
    v_pk_fma_f32 v[156:157], v[148:149], 0.5, 1.0 op_sel_hi:[1,0,0]
    v_pk_fma_f32 v[158:159], v[150:151], 0.5, 1.0 op_sel_hi:[1,0,0]
    v_pk_fma_f32 v[144:145], v[144:145], v[152:153], 1.0 op_sel_hi:[1,1,0]
    v_pk_fma_f32 v[146:147], v[146:147], v[154:155], 1.0 op_sel_hi:[1,1,0]
    v_pk_fma_f32 v[148:149], v[148:149], v[156:157], 1.0 op_sel_hi:[1,1,0]
    v_pk_fma_f32 v[150:151], v[150:151], v[158:159], 1.0 op_sel_hi:[1,1,0]
    v_rcp_f32 v144, v144
    v_rcp_f32 v145, v145
    v_rcp_f32 v146, v146
    v_rcp_f32 v147, v147
    v_rcp_f32 v148, v148
    v_rcp_f32 v149, v149
    v_rcp_f32 v150, v150
    v_rcp_f32 v151, v151
    v_pk_fma_f32 v[144:145], v[112:113], v[144:145], v[112:113] neg_lo:[1,0,0] neg_hi:[1,0,0]
    v_pk_fma_f32 v[146:147], v[114:115], v[146:147], v[114:115] neg_lo:[1,0,0] neg_hi:[1,0,0]
    v_pk_fma_f32 v[148:149], v[116:117], v[148:149], v[116:117] neg_lo:[1,0,0] neg_hi:[1,0,0]
    v_pk_fma_f32 v[150:151], v[118:119], v[150:151], v[118:119] neg_lo:[1,0,0] neg_hi:[1,0,0]
    v_cvt_pk_bf16_f32 v160, v144, v145
    v_cvt_pk_bf16_f32 v161, v146, v147
    v_cvt_pk_bf16_f32 v162, v148, v149
    v_cvt_pk_bf16_f32 v163, v150, v151
    buffer_store_dwordx4 v[160:163], v2, s[60:63], s69 offen offset:2048 sc1
    v_pk_mul_f32 v[144:145], v[120:121], s[72:73] op_sel_hi:[1,0]
    v_pk_mul_f32 v[146:147], v[122:123], s[72:73] op_sel_hi:[1,0]
    v_pk_mul_f32 v[148:149], v[124:125], s[72:73] op_sel_hi:[1,0]
    v_pk_mul_f32 v[150:151], v[126:127], s[72:73] op_sel_hi:[1,0]
    v_exp_f32 v144, v144
    v_exp_f32 v145, v145
    v_exp_f32 v146, v146
    v_exp_f32 v147, v147
    v_exp_f32 v148, v148
    v_exp_f32 v149, v149
    v_exp_f32 v150, v150
    v_exp_f32 v151, v151
    v_pk_fma_f32 v[152:153], v[144:145], 0.5, 1.0 op_sel_hi:[1,0,0]
    v_pk_fma_f32 v[154:155], v[146:147], 0.5, 1.0 op_sel_hi:[1,0,0]
    v_pk_fma_f32 v[156:157], v[148:149], 0.5, 1.0 op_sel_hi:[1,0,0]
    v_pk_fma_f32 v[158:159], v[150:151], 0.5, 1.0 op_sel_hi:[1,0,0]
    v_pk_fma_f32 v[144:145], v[144:145], v[152:153], 1.0 op_sel_hi:[1,1,0]
    v_pk_fma_f32 v[146:147], v[146:147], v[154:155], 1.0 op_sel_hi:[1,1,0]
    v_pk_fma_f32 v[148:149], v[148:149], v[156:157], 1.0 op_sel_hi:[1,1,0]
    v_pk_fma_f32 v[150:151], v[150:151], v[158:159], 1.0 op_sel_hi:[1,1,0]
    v_rcp_f32 v144, v144
    v_rcp_f32 v145, v145
    v_rcp_f32 v146, v146
    v_rcp_f32 v147, v147
    v_rcp_f32 v148, v148
    v_rcp_f32 v149, v149
    v_rcp_f32 v150, v150
    v_rcp_f32 v151, v151
    v_pk_fma_f32 v[144:145], v[120:121], v[144:145], v[120:121] neg_lo:[1,0,0] neg_hi:[1,0,0]
    v_pk_fma_f32 v[146:147], v[122:123], v[146:147], v[122:123] neg_lo:[1,0,0] neg_hi:[1,0,0]
    v_pk_fma_f32 v[148:149], v[124:125], v[148:149], v[124:125] neg_lo:[1,0,0] neg_hi:[1,0,0]
    v_pk_fma_f32 v[150:151], v[126:127], v[150:151], v[126:127] neg_lo:[1,0,0] neg_hi:[1,0,0]
    v_cvt_pk_bf16_f32 v164, v144, v145
    v_cvt_pk_bf16_f32 v165, v146, v147
    v_cvt_pk_bf16_f32 v166, v148, v149
    v_cvt_pk_bf16_f32 v167, v150, v151
    buffer_store_dwordx4 v[164:167], v2, s[60:63], s69 offen offset:3072 sc1
    v_pk_mul_f32 v[144:145], v[128:129], s[72:73] op_sel_hi:[1,0]
    v_pk_mul_f32 v[146:147], v[130:131], s[72:73] op_sel_hi:[1,0]
    v_pk_mul_f32 v[148:149], v[132:133], s[72:73] op_sel_hi:[1,0]
    v_pk_mul_f32 v[150:151], v[134:135], s[72:73] op_sel_hi:[1,0]
    v_exp_f32 v144, v144
    v_exp_f32 v145, v145
    v_exp_f32 v146, v146
    v_exp_f32 v147, v147
    v_exp_f32 v148, v148
    v_exp_f32 v149, v149
    v_exp_f32 v150, v150
    v_exp_f32 v151, v151
    v_pk_fma_f32 v[152:153], v[144:145], 0.5, 1.0 op_sel_hi:[1,0,0]
    v_pk_fma_f32 v[154:155], v[146:147], 0.5, 1.0 op_sel_hi:[1,0,0]
    v_pk_fma_f32 v[156:157], v[148:149], 0.5, 1.0 op_sel_hi:[1,0,0]
    v_pk_fma_f32 v[158:159], v[150:151], 0.5, 1.0 op_sel_hi:[1,0,0]
    v_pk_fma_f32 v[144:145], v[144:145], v[152:153], 1.0 op_sel_hi:[1,1,0]
    v_pk_fma_f32 v[146:147], v[146:147], v[154:155], 1.0 op_sel_hi:[1,1,0]
    v_pk_fma_f32 v[148:149], v[148:149], v[156:157], 1.0 op_sel_hi:[1,1,0]
    v_pk_fma_f32 v[150:151], v[150:151], v[158:159], 1.0 op_sel_hi:[1,1,0]
    v_rcp_f32 v144, v144
    v_rcp_f32 v145, v145
    v_rcp_f32 v146, v146
    v_rcp_f32 v147, v147
    v_rcp_f32 v148, v148
    v_rcp_f32 v149, v149
    v_rcp_f32 v150, v150
    v_rcp_f32 v151, v151
    v_pk_fma_f32 v[144:145], v[128:129], v[144:145], v[128:129] neg_lo:[1,0,0] neg_hi:[1,0,0]
    v_pk_fma_f32 v[146:147], v[130:131], v[146:147], v[130:131] neg_lo:[1,0,0] neg_hi:[1,0,0]
    v_pk_fma_f32 v[148:149], v[132:133], v[148:149], v[132:133] neg_lo:[1,0,0] neg_hi:[1,0,0]
    v_pk_fma_f32 v[150:151], v[134:135], v[150:151], v[134:135] neg_lo:[1,0,0] neg_hi:[1,0,0]
    v_cvt_pk_bf16_f32 v160, v144, v145
    v_cvt_pk_bf16_f32 v161, v146, v147
    v_cvt_pk_bf16_f32 v162, v148, v149
    v_cvt_pk_bf16_f32 v163, v150, v151
    buffer_store_dwordx4 v[160:163], v2, s[60:63], s17 offen offset:0 sc1
    v_pk_mul_f32 v[144:145], v[136:137], s[72:73] op_sel_hi:[1,0]
    v_pk_mul_f32 v[146:147], v[138:139], s[72:73] op_sel_hi:[1,0]
    v_pk_mul_f32 v[148:149], v[140:141], s[72:73] op_sel_hi:[1,0]
    v_pk_mul_f32 v[150:151], v[142:143], s[72:73] op_sel_hi:[1,0]
    v_exp_f32 v144, v144
    v_exp_f32 v145, v145
    v_exp_f32 v146, v146
    v_exp_f32 v147, v147
    v_exp_f32 v148, v148
    v_exp_f32 v149, v149
    v_exp_f32 v150, v150
    v_exp_f32 v151, v151
    v_pk_fma_f32 v[152:153], v[144:145], 0.5, 1.0 op_sel_hi:[1,0,0]
    v_pk_fma_f32 v[154:155], v[146:147], 0.5, 1.0 op_sel_hi:[1,0,0]
    v_pk_fma_f32 v[156:157], v[148:149], 0.5, 1.0 op_sel_hi:[1,0,0]
    v_pk_fma_f32 v[158:159], v[150:151], 0.5, 1.0 op_sel_hi:[1,0,0]
    v_pk_fma_f32 v[144:145], v[144:145], v[152:153], 1.0 op_sel_hi:[1,1,0]
    v_pk_fma_f32 v[146:147], v[146:147], v[154:155], 1.0 op_sel_hi:[1,1,0]
    v_pk_fma_f32 v[148:149], v[148:149], v[156:157], 1.0 op_sel_hi:[1,1,0]
    v_pk_fma_f32 v[150:151], v[150:151], v[158:159], 1.0 op_sel_hi:[1,1,0]
    v_rcp_f32 v144, v144
    v_rcp_f32 v145, v145
    v_rcp_f32 v146, v146
    v_rcp_f32 v147, v147
    v_rcp_f32 v148, v148
    v_rcp_f32 v149, v149
    v_rcp_f32 v150, v150
    v_rcp_f32 v151, v151
    v_pk_fma_f32 v[144:145], v[136:137], v[144:145], v[136:137] neg_lo:[1,0,0] neg_hi:[1,0,0]
    v_pk_fma_f32 v[146:147], v[138:139], v[146:147], v[138:139] neg_lo:[1,0,0] neg_hi:[1,0,0]
    v_pk_fma_f32 v[148:149], v[140:141], v[148:149], v[140:141] neg_lo:[1,0,0] neg_hi:[1,0,0]
    v_pk_fma_f32 v[150:151], v[142:143], v[150:151], v[142:143] neg_lo:[1,0,0] neg_hi:[1,0,0]
    v_cvt_pk_bf16_f32 v164, v144, v145
    v_cvt_pk_bf16_f32 v165, v146, v147
    v_cvt_pk_bf16_f32 v166, v148, v149
    v_cvt_pk_bf16_f32 v167, v150, v151
    buffer_store_dwordx4 v[164:167], v2, s[60:63], s17 offen offset:1024 sc1
    s_setprio 0
    s_lshl2_add_u32 s27, s5, s4
    s_lshl4_add_u32 s27, s27, s6
    s_lshl_b32 s27, s27, 4
    v_mov_b32 v28, s12
    s_waitcnt vmcnt(0)
    v_cmp_eq_u32 vcc, 0, v1
    v_mov_b32 v24, 0x40000000
    v_mov_b32 v26, 12779520
    v_cndmask_b32 v24, v24, v26, vcc
    v_add_u32 v26, 2, v28
    buffer_store_dword v26, v24, s[60:63], s27 offen sc1
    s_lshl_b32 s27, s9, 9
    s_add_u32 s27, s27, 12779520
    v_and_b32 v26, 31, v1
    v_lshlrev_b32 v26, 4, v26
    s_add_u32 s26, s12, 2
    v_readlane_b32 s22, v20, 2
    s_add_u32 m0, s70, 98304
    s_nop 3
    buffer_load_dwordx4 v25, s[48:51], s22 offen offset:0  lds
    buffer_load_dwordx4 v27, s[48:51], s22 offen offset:1024  lds
    buffer_load_dwordx4 v29, s[48:51], s22 offen offset:2048  lds
    buffer_load_dwordx4 v31, s[48:51], s22 offen offset:3072  lds
    v_readlane_b32 s23, v20, 3
    s_add_u32 m0, s70, 16384
    s_nop 3
    buffer_load_dwordx4 v25, s[48:51], s23 offen offset:0  lds
    buffer_load_dwordx4 v27, s[48:51], s23 offen offset:1024  lds
    buffer_load_dwordx4 v29, s[48:51], s23 offen offset:2048  lds
    buffer_load_dwordx4 v31, s[48:51], s23 offen offset:3072  lds
    v_readlane_b32 s22, v20, 4
    s_add_u32 m0, s70, 32768
    s_nop 3
    buffer_load_dwordx4 v25, s[48:51], s22 offen offset:0  lds
    buffer_load_dwordx4 v27, s[48:51], s22 offen offset:1024  lds
    buffer_load_dwordx4 v29, s[48:51], s22 offen offset:2048  lds
    buffer_load_dwordx4 v31, s[48:51], s22 offen offset:3072  lds
    v_readlane_b32 s23, v20, 5
    s_add_u32 m0, s70, 49152
    s_nop 3
    buffer_load_dwordx4 v25, s[48:51], s23 offen offset:0  lds
    buffer_load_dwordx4 v27, s[48:51], s23 offen offset:1024  lds
    buffer_load_dwordx4 v29, s[48:51], s23 offen offset:2048  lds
    buffer_load_dwordx4 v31, s[48:51], s23 offen offset:3072  lds
    v_readlane_b32 s22, v20, 6
    s_add_u32 m0, s70, 65536
    s_nop 3
    buffer_load_dwordx4 v25, s[48:51], s22 offen offset:0  lds
    buffer_load_dwordx4 v27, s[48:51], s22 offen offset:1024  lds
    buffer_load_dwordx4 v29, s[48:51], s22 offen offset:2048  lds
    buffer_load_dwordx4 v31, s[48:51], s22 offen offset:3072  lds
    v_readlane_b32 s23, v20, 7
    s_add_u32 m0, s70, 81920
    s_nop 3
    buffer_load_dwordx4 v25, s[48:51], s23 offen offset:0  lds
    buffer_load_dwordx4 v27, s[48:51], s23 offen offset:1024  lds
    buffer_load_dwordx4 v29, s[48:51], s23 offen offset:2048  lds
    buffer_load_dwordx4 v31, s[48:51], s23 offen offset:3072  lds
    s_mov_b32 s14, 0
L_pi_24:
    buffer_load_dword v24, v26, s[60:63], s27 offen sc1
    s_add_u32 s14, s14, 1
    s_cmp_gt_u32 s14, 200000
    s_waitcnt vmcnt(0)
    v_cmp_ne_u32 vcc, s26, v24
    s_cbranch_scc1 L_pie_25
    s_and_b64 exec, vcc, vcc
    s_cbranch_scc1 L_pi_24
L_pie_25:
    s_mov_b64 exec, -1
    s_lshl2_add_u32 s26, s4, 8272
    v_mov_b32 v22, s26
    v_mov_b32 v23, 1
    v_readlane_b32 s24, v21, 0
    s_nop 0
    s_add_u32 s25, s24, 88064
    s_nop 2
    buffer_load_dwordx4 a[0:3], v2, s[60:63], s24 offen offset:0 sc1
    buffer_load_dwordx4 a[8:11], v2, s[60:63], s25 offen offset:0 sc1
    buffer_load_dwordx4 a[4:7], v2, s[60:63], s24 offen offset:1024 sc1
    buffer_load_dwordx4 a[12:15], v2, s[60:63], s25 offen offset:1024 sc1
    v_readlane_b32 s24, v21, 1
    s_nop 0
    s_add_u32 s25, s24, 88064
    s_nop 2
    buffer_load_dwordx4 a[16:19], v2, s[60:63], s24 offen offset:0 sc1
    buffer_load_dwordx4 a[24:27], v2, s[60:63], s25 offen offset:0 sc1
    buffer_load_dwordx4 a[20:23], v2, s[60:63], s24 offen offset:1024 sc1
    buffer_load_dwordx4 a[28:31], v2, s[60:63], s25 offen offset:1024 sc1
    v_readlane_b32 s24, v21, 2
    s_nop 0
    s_add_u32 s25, s24, 88064
    s_nop 2
    buffer_load_dwordx4 a[32:35], v2, s[60:63], s24 offen offset:0 sc1
    buffer_load_dwordx4 a[40:43], v2, s[60:63], s25 offen offset:0 sc1
    buffer_load_dwordx4 a[36:39], v2, s[60:63], s24 offen offset:1024 sc1
    buffer_load_dwordx4 a[44:47], v2, s[60:63], s25 offen offset:1024 sc1
    s_lshl2_add_u32 s14, s4, 8256
    v_mov_b32 v30, s14
    s_mov_b32 s14, 0
L_bs_26:
    ds_read_b32 v3, v30
    s_add_u32 s14, s14, 1
    s_waitcnt lgkmcnt(0)
    v_cmp_ne_u32 vcc, 1, v3
    s_cmp_gt_u32 s14, 2000000
    s_cbranch_scc1 L_bse_27
    s_cbranch_vccnz L_bs_26
L_bse_27:
    v_bfe_u32 v4, v0, 3, 3
    v_and_b32 v3, 7, v0
    v_lshlrev_b32 v5, 1, v3
    v_xor_b32 v5, v5, v4
    v_lshlrev_b32 v5, 4, v5
    v_bfe_u32 v6, v0, 3, 4
    v_lshl_add_u32 v5, v6, 8, v5
    s_lshr_b32 s14, s4, 1
    s_lshl_b32 s14, s14, 14
    s_add_u32 s14, s14, 98304
    v_add_u32 v5, s14, v5
    v_xor_b32 v6, 16, v5
    v_and_b32 v7, 3, v4
    v_lshlrev_b32 v7, 2, v7
    v_bfe_u32 v9, v0, 5, 1
    v_lshl_add_u32 v7, v9, 10, v7
    v_lshlrev_b32 v4, 10, v4
    v_lshl_add_u32 v4, v3, 4, v4
    s_lshr_b32 s77, s9, 2
    s_lshl_b32 s77, s77, 18
    s_and_b32 s15, s9, 3
    s_lshl_b32 s15, s15, 13
    s_add_u32 s77, s77, s15
    s_lshl_b32 s15, s10, 7
    s_add_u32 s77, s77, s15
    s_add_u32 s16, s4, 0
    s_lshl_b32 s15, s16, 15
    s_add_u32 s77, s77, s15
    s_and_b32 s15, s9, 3
    s_bfe_u32 s17, s9, 0x10002
    s_lshl1_add_u32 s15, s15, s17
    s_lshl3_add_u32 s15, s15, s16
    s_lshr_b32 s17, s9, 3
    s_lshl_b32 s17, s17, 11
    s_lshl4_add_u32 s15, s15, s17
    s_add_u32 s15, s15, 12582912
    buffer_load_dword v8, v7, s[60:63], s15 offen sc1
    v_and_b32 v30, 7, v1
    v_lshrrev_b32 v3, 5, v1
    v_xor_b32 v30, v30, v3
    v_lshlrev_b32 v30, 4, v30
    v_and_b32 v3, 15, v1
    v_lshl_add_u32 v30, v3, 8, v30
    v_bfe_u32 v3, v1, 4, 1
    v_lshl_add_u32 v30, v3, 14, v30
    s_add_u32 s14, s70, 98304
    v_add_u32 v18, s14, v30
    v_xor_b32 v19, 32, v18
    v_xor_b32 v24, 64, v18
    v_xor_b32 v26, 96, v18
    ds_read_b64_tr_b16 v[160:161], v10 offset:49152
    ds_read_b64_tr_b16 v[162:163], v10 offset:50176
    ds_read_b64_tr_b16 v[164:165], v11 offset:49152
    ds_read_b64_tr_b16 v[166:167], v11 offset:50176
    s_waitcnt vmcnt(11) lgkmcnt(2)
    v_mfma_f32_32x32x16_bf16 v[96:111], v[160:163], a[0:3], 0
    ds_read_b64_tr_b16 v[168:169], v10 offset:51200
    ds_read_b64_tr_b16 v[170:171], v10 offset:52224
    v_readlane_b32 s24, v21, 3
    s_nop 0
    s_add_u32 s25, s24, 88064
    v_mfma_f32_32x32x16_bf16 v[112:127], v[160:163], a[8:11], 0
    s_waitcnt lgkmcnt(2)
    v_mfma_f32_32x32x16_bf16 v[128:143], v[164:167], a[0:3], 0
    ds_read_b64_tr_b16 v[172:173], v11 offset:51200
    ds_read_b64_tr_b16 v[174:175], v11 offset:52224
    v_mfma_f32_32x32x16_bf16 v[144:159], v[164:167], a[8:11], 0
    buffer_load_dwordx4 a[48:51], v2, s[60:63], s24 offen offset:0 sc1
    buffer_load_dwordx4 a[56:59], v2, s[60:63], s25 offen offset:0 sc1
    s_waitcnt vmcnt(11) lgkmcnt(2)
    v_mfma_f32_32x32x16_bf16 v[96:111], v[168:171], a[4:7], v[96:111]
    ds_read_b64_tr_b16 v[160:161], v12 offset:0
    ds_read_b64_tr_b16 v[162:163], v12 offset:1024
    v_mfma_f32_32x32x16_bf16 v[112:127], v[168:171], a[12:15], v[112:127]
    s_waitcnt lgkmcnt(2)
    v_mfma_f32_32x32x16_bf16 v[128:143], v[172:175], a[4:7], v[128:143]
    ds_read_b64_tr_b16 v[164:165], v13 offset:0
    ds_read_b64_tr_b16 v[166:167], v13 offset:1024
    v_mfma_f32_32x32x16_bf16 v[144:159], v[172:175], a[12:15], v[144:159]
    buffer_load_dwordx4 a[52:55], v2, s[60:63], s24 offen offset:1024 sc1
    buffer_load_dwordx4 a[60:63], v2, s[60:63], s25 offen offset:1024 sc1
    s_waitcnt vmcnt(11) lgkmcnt(2)
    v_mfma_f32_32x32x16_bf16 v[96:111], v[160:163], a[16:19], v[96:111]
    ds_read_b64_tr_b16 v[168:169], v12 offset:2048
    ds_read_b64_tr_b16 v[170:171], v12 offset:3072
    v_readlane_b32 s24, v21, 4
    s_nop 0
    s_add_u32 s25, s24, 88064
    v_mfma_f32_32x32x16_bf16 v[112:127], v[160:163], a[24:27], v[112:127]
    s_waitcnt lgkmcnt(2)
    v_mfma_f32_32x32x16_bf16 v[128:143], v[164:167], a[16:19], v[128:143]
    ds_read_b64_tr_b16 v[172:173], v13 offset:2048
    ds_read_b64_tr_b16 v[174:175], v13 offset:3072
    v_mfma_f32_32x32x16_bf16 v[144:159], v[164:167], a[24:27], v[144:159]
    buffer_load_dwordx4 a[0:3], v2, s[60:63], s24 offen offset:0 sc1
    buffer_load_dwordx4 a[8:11], v2, s[60:63], s25 offen offset:0 sc1
    s_waitcnt vmcnt(11) lgkmcnt(2)
    v_mfma_f32_32x32x16_bf16 v[96:111], v[168:171], a[20:23], v[96:111]
    ds_read_b64_tr_b16 v[160:161], v10 offset:32768
    ds_read_b64_tr_b16 v[162:163], v10 offset:33792
    v_mfma_f32_32x32x16_bf16 v[112:127], v[168:171], a[28:31], v[112:127]
    s_waitcnt lgkmcnt(2)
    v_mfma_f32_32x32x16_bf16 v[128:143], v[172:175], a[20:23], v[128:143]
    ds_read_b64_tr_b16 v[164:165], v11 offset:32768
    ds_read_b64_tr_b16 v[166:167], v11 offset:33792
    v_mfma_f32_32x32x16_bf16 v[144:159], v[172:175], a[28:31], v[144:159]
    buffer_load_dwordx4 a[4:7], v2, s[60:63], s24 offen offset:1024 sc1
    buffer_load_dwordx4 a[12:15], v2, s[60:63], s25 offen offset:1024 sc1
    s_waitcnt vmcnt(11) lgkmcnt(2)
    v_mfma_f32_32x32x16_bf16 v[96:111], v[160:163], a[32:35], v[96:111]
    ds_read_b64_tr_b16 v[168:169], v10 offset:34816
    ds_read_b64_tr_b16 v[170:171], v10 offset:35840
    v_readlane_b32 s24, v21, 5
    s_nop 0
    s_add_u32 s25, s24, 88064
    v_mfma_f32_32x32x16_bf16 v[112:127], v[160:163], a[40:43], v[112:127]
    s_waitcnt lgkmcnt(2)
    v_mfma_f32_32x32x16_bf16 v[128:143], v[164:167], a[32:35], v[128:143]
    ds_read_b64_tr_b16 v[172:173], v11 offset:34816
    ds_read_b64_tr_b16 v[174:175], v11 offset:35840
    v_mfma_f32_32x32x16_bf16 v[144:159], v[164:167], a[40:43], v[144:159]
    buffer_load_dwordx4 a[16:19], v2, s[60:63], s24 offen offset:0 sc1
    buffer_load_dwordx4 a[24:27], v2, s[60:63], s25 offen offset:0 sc1
    s_waitcnt vmcnt(11) lgkmcnt(2)
    v_mfma_f32_32x32x16_bf16 v[96:111], v[168:171], a[36:39], v[96:111]
    ds_read_b64_tr_b16 v[160:161], v14 offset:16384
    ds_read_b64_tr_b16 v[162:163], v14 offset:17408
    v_mfma_f32_32x32x16_bf16 v[112:127], v[168:171], a[44:47], v[112:127]
    s_waitcnt lgkmcnt(2)
    v_mfma_f32_32x32x16_bf16 v[128:143], v[172:175], a[36:39], v[128:143]
    ds_read_b64_tr_b16 v[164:165], v15 offset:16384
    ds_read_b64_tr_b16 v[166:167], v15 offset:17408
    v_mfma_f32_32x32x16_bf16 v[144:159], v[172:175], a[44:47], v[144:159]
    buffer_load_dwordx4 a[20:23], v2, s[60:63], s24 offen offset:1024 sc1
    buffer_load_dwordx4 a[28:31], v2, s[60:63], s25 offen offset:1024 sc1
    ds_write_b32 v22, v23
    s_waitcnt vmcnt(10) lgkmcnt(3)
    v_mfma_f32_32x32x16_bf16 v[96:111], v[160:163], a[48:51], v[96:111]
    ds_read_b64_tr_b16 v[168:169], v14 offset:18432
    ds_read_b64_tr_b16 v[170:171], v14 offset:19456
    v_readlane_b32 s24, v21, 6
    s_nop 0
    s_add_u32 s25, s24, 88064
    v_mfma_f32_32x32x16_bf16 v[112:127], v[160:163], a[56:59], v[112:127]
    s_waitcnt lgkmcnt(3)
    v_mfma_f32_32x32x16_bf16 v[128:143], v[164:167], a[48:51], v[128:143]
    ds_read_b64_tr_b16 v[172:173], v15 offset:18432
    ds_read_b64_tr_b16 v[174:175], v15 offset:19456
    v_mfma_f32_32x32x16_bf16 v[144:159], v[164:167], a[56:59], v[144:159]
    buffer_load_dwordx4 a[32:35], v2, s[60:63], s24 offen offset:0 sc1
    buffer_load_dwordx4 a[40:43], v2, s[60:63], s25 offen offset:0 sc1
    s_waitcnt vmcnt(10) lgkmcnt(2)
    v_mfma_f32_32x32x16_bf16 v[96:111], v[168:171], a[52:55], v[96:111]
    ds_read_b64_tr_b16 v[160:161], v14 offset:32768
    ds_read_b64_tr_b16 v[162:163], v14 offset:33792
    v_mfma_f32_32x32x16_bf16 v[112:127], v[168:171], a[60:63], v[112:127]
    s_waitcnt lgkmcnt(2)
    v_mfma_f32_32x32x16_bf16 v[128:143], v[172:175], a[52:55], v[128:143]
    ds_read_b64_tr_b16 v[164:165], v15 offset:32768
    ds_read_b64_tr_b16 v[166:167], v15 offset:33792
    v_mfma_f32_32x32x16_bf16 v[144:159], v[172:175], a[60:63], v[144:159]
    buffer_load_dwordx4 a[36:39], v2, s[60:63], s24 offen offset:1024 sc1
    buffer_load_dwordx4 a[44:47], v2, s[60:63], s25 offen offset:1024 sc1
    s_waitcnt vmcnt(10) lgkmcnt(2)
    v_mfma_f32_32x32x16_bf16 v[96:111], v[160:163], a[0:3], v[96:111]
    ds_read_b64_tr_b16 v[168:169], v14 offset:34816
    ds_read_b64_tr_b16 v[170:171], v14 offset:35840
    v_readlane_b32 s24, v21, 7
    s_nop 0
    s_add_u32 s25, s24, 88064
    v_mfma_f32_32x32x16_bf16 v[112:127], v[160:163], a[8:11], v[112:127]
    s_waitcnt lgkmcnt(2)
    v_mfma_f32_32x32x16_bf16 v[128:143], v[164:167], a[0:3], v[128:143]
    ds_read_b64_tr_b16 v[172:173], v15 offset:34816
    ds_read_b64_tr_b16 v[174:175], v15 offset:35840
    v_mfma_f32_32x32x16_bf16 v[144:159], v[164:167], a[8:11], v[144:159]
    buffer_load_dwordx4 a[48:51], v2, s[60:63], s24 offen offset:0 sc1
    buffer_load_dwordx4 a[56:59], v2, s[60:63], s25 offen offset:0 sc1
    s_waitcnt vmcnt(10) lgkmcnt(2)
    v_mfma_f32_32x32x16_bf16 v[96:111], v[168:171], a[4:7], v[96:111]
    ds_read_b64_tr_b16 v[160:161], v14 offset:49152
    ds_read_b64_tr_b16 v[162:163], v14 offset:50176
    v_mfma_f32_32x32x16_bf16 v[112:127], v[168:171], a[12:15], v[112:127]
    s_waitcnt lgkmcnt(2)
    v_mfma_f32_32x32x16_bf16 v[128:143], v[172:175], a[4:7], v[128:143]
    ds_read_b64_tr_b16 v[164:165], v15 offset:49152
    ds_read_b64_tr_b16 v[166:167], v15 offset:50176
    v_mfma_f32_32x32x16_bf16 v[144:159], v[172:175], a[12:15], v[144:159]
    buffer_load_dwordx4 a[52:55], v2, s[60:63], s24 offen offset:1024 sc1
    buffer_load_dwordx4 a[60:63], v2, s[60:63], s25 offen offset:1024 sc1
    s_waitcnt vmcnt(10) lgkmcnt(2)
    v_mfma_f32_32x32x16_bf16 v[96:111], v[160:163], a[16:19], v[96:111]
    ds_read_b64_tr_b16 v[168:169], v14 offset:51200
    ds_read_b64_tr_b16 v[170:171], v14 offset:52224
    v_mfma_f32_32x32x16_bf16 v[112:127], v[160:163], a[24:27], v[112:127]
    s_waitcnt lgkmcnt(2)
    v_mfma_f32_32x32x16_bf16 v[128:143], v[164:167], a[16:19], v[128:143]
    ds_read_b64_tr_b16 v[172:173], v15 offset:51200
    ds_read_b64_tr_b16 v[174:175], v15 offset:52224
    v_mfma_f32_32x32x16_bf16 v[144:159], v[164:167], a[24:27], v[144:159]
    s_waitcnt vmcnt(8) lgkmcnt(2)
    v_mfma_f32_32x32x16_bf16 v[96:111], v[168:171], a[20:23], v[96:111]
    ds_read_b64_tr_b16 v[160:161], v10 offset:0
    ds_read_b64_tr_b16 v[162:163], v10 offset:1024
    v_mfma_f32_32x32x16_bf16 v[112:127], v[168:171], a[28:31], v[112:127]
    s_waitcnt lgkmcnt(2)
    v_mfma_f32_32x32x16_bf16 v[128:143], v[172:175], a[20:23], v[128:143]
    ds_read_b64_tr_b16 v[164:165], v11 offset:0
    ds_read_b64_tr_b16 v[166:167], v11 offset:1024
    v_mfma_f32_32x32x16_bf16 v[144:159], v[172:175], a[28:31], v[144:159]
    s_waitcnt vmcnt(6) lgkmcnt(2)
    v_mfma_f32_32x32x16_bf16 v[96:111], v[160:163], a[32:35], v[96:111]
    ds_read_b64_tr_b16 v[168:169], v10 offset:2048
    ds_read_b64_tr_b16 v[170:171], v10 offset:3072
    v_mfma_f32_32x32x16_bf16 v[112:127], v[160:163], a[40:43], v[112:127]
    s_waitcnt lgkmcnt(2)
    v_mfma_f32_32x32x16_bf16 v[128:143], v[164:167], a[32:35], v[128:143]
    ds_read_b64_tr_b16 v[172:173], v11 offset:2048
    ds_read_b64_tr_b16 v[174:175], v11 offset:3072
    v_mfma_f32_32x32x16_bf16 v[144:159], v[164:167], a[40:43], v[144:159]
    s_waitcnt vmcnt(4) lgkmcnt(2)
    v_mfma_f32_32x32x16_bf16 v[96:111], v[168:171], a[36:39], v[96:111]
    ds_read_b64_tr_b16 v[160:161], v10 offset:16384
    ds_read_b64_tr_b16 v[162:163], v10 offset:17408
    v_mfma_f32_32x32x16_bf16 v[112:127], v[168:171], a[44:47], v[112:127]
    s_waitcnt lgkmcnt(2)
    v_mfma_f32_32x32x16_bf16 v[128:143], v[172:175], a[36:39], v[128:143]
    ds_read_b64_tr_b16 v[164:165], v11 offset:16384
    ds_read_b64_tr_b16 v[166:167], v11 offset:17408
    v_mfma_f32_32x32x16_bf16 v[144:159], v[172:175], a[44:47], v[144:159]
    s_barrier
    ds_read_b64_tr_b16 a[64:65], v16 offset:0
    ds_read_b64_tr_b16 a[66:67], v16 offset:512
    ds_read_b64_tr_b16 a[68:69], v17 offset:0
    ds_read_b64_tr_b16 a[70:71], v17 offset:512
    s_waitcnt lgkmcnt(2)
    v_mfma_f32_32x32x16_bf16 v[96:111], v[32:35], a[64:67], v[96:111]
    v_readlane_b32 s22, v20, 8
    ds_read_b64_tr_b16 a[72:73], v16 offset:1024
    ds_read_b64_tr_b16 a[74:75], v16 offset:1536
    v_mfma_f32_32x32x16_bf16 v[128:143], v[36:39], a[64:67], v[128:143]
    s_add_u32 m0, s70, 16384
    s_waitcnt lgkmcnt(2)
    v_mfma_f32_32x32x16_bf16 v[112:127], v[32:35], a[68:71], v[112:127]
    buffer_load_dwordx4 v25, s[48:51], s22 offen offset:0  lds
    ds_read_b64_tr_b16 a[76:77], v17 offset:1024
    ds_read_b64_tr_b16 a[78:79], v17 offset:1536
    v_mfma_f32_32x32x16_bf16 v[144:159], v[36:39], a[68:71], v[144:159]
    buffer_load_dwordx4 v27, s[48:51], s22 offen offset:1024  lds
    s_waitcnt lgkmcnt(2)
    v_mfma_f32_32x32x16_bf16 v[96:111], v[40:43], a[72:75], v[96:111]
    buffer_load_dwordx4 v29, s[48:51], s22 offen offset:2048  lds
    ds_read_b64_tr_b16 a[64:65], v16 offset:2048
    ds_read_b64_tr_b16 a[66:67], v16 offset:2560
    v_mfma_f32_32x32x16_bf16 v[128:143], v[44:47], a[72:75], v[128:143]
    buffer_load_dwordx4 v31, s[48:51], s22 offen offset:3072  lds
    s_waitcnt lgkmcnt(2)
    v_mfma_f32_32x32x16_bf16 v[112:127], v[40:43], a[76:79], v[112:127]
    v_readlane_b32 s24, v21, 8
    ds_read_b64_tr_b16 a[68:69], v17 offset:2048
    ds_read_b64_tr_b16 a[70:71], v17 offset:2560
    v_mfma_f32_32x32x16_bf16 v[144:159], v[44:47], a[76:79], v[144:159]
    s_add_u32 s25, s24, 88064
    s_waitcnt lgkmcnt(2)
    v_mfma_f32_32x32x16_bf16 v[96:111], v[48:51], a[64:67], v[96:111]
    buffer_load_dwordx4 a[0:3], v2, s[60:63], s24 offen offset:0 sc1
    ds_read_b64_tr_b16 a[72:73], v16 offset:3072
    ds_read_b64_tr_b16 a[74:75], v16 offset:3584
    v_mfma_f32_32x32x16_bf16 v[128:143], v[52:55], a[64:67], v[128:143]
    buffer_load_dwordx4 a[8:11], v2, s[60:63], s25 offen offset:0 sc1
    s_waitcnt lgkmcnt(2)
    v_mfma_f32_32x32x16_bf16 v[112:127], v[48:51], a[68:71], v[112:127]
    buffer_load_dwordx4 a[4:7], v2, s[60:63], s24 offen offset:1024 sc1
    ds_read_b64_tr_b16 a[76:77], v17 offset:3072
    ds_read_b64_tr_b16 a[78:79], v17 offset:3584
    v_mfma_f32_32x32x16_bf16 v[144:159], v[52:55], a[68:71], v[144:159]
    buffer_load_dwordx4 a[12:15], v2, s[60:63], s25 offen offset:1024 sc1
    s_waitcnt lgkmcnt(2)
    v_mfma_f32_32x32x16_bf16 v[96:111], v[56:59], a[72:75], v[96:111]
    v_readlane_b32 s23, v20, 9
    s_barrier
    ds_read_b64_tr_b16 a[64:65], v16 offset:16384
    ds_read_b64_tr_b16 a[66:67], v16 offset:16896
    v_mfma_f32_32x32x16_bf16 v[128:143], v[60:63], a[72:75], v[128:143]
    s_add_u32 m0, s70, 32768
    s_waitcnt lgkmcnt(2)
    v_mfma_f32_32x32x16_bf16 v[112:127], v[56:59], a[76:79], v[112:127]
    buffer_load_dwordx4 v25, s[48:51], s23 offen offset:0  lds
    ds_read_b64_tr_b16 a[68:69], v17 offset:16384
    ds_read_b64_tr_b16 a[70:71], v17 offset:16896
    v_mfma_f32_32x32x16_bf16 v[144:159], v[60:63], a[76:79], v[144:159]
    buffer_load_dwordx4 v27, s[48:51], s23 offen offset:1024  lds
    s_waitcnt lgkmcnt(2)
    v_mfma_f32_32x32x16_bf16 v[96:111], v[64:67], a[64:67], v[96:111]
    buffer_load_dwordx4 v29, s[48:51], s23 offen offset:2048  lds
    ds_read_b64_tr_b16 a[72:73], v16 offset:17408
    ds_read_b64_tr_b16 a[74:75], v16 offset:17920
    v_mfma_f32_32x32x16_bf16 v[128:143], v[68:71], a[64:67], v[128:143]
    buffer_load_dwordx4 v31, s[48:51], s23 offen offset:3072  lds
    s_waitcnt lgkmcnt(2)
    v_mfma_f32_32x32x16_bf16 v[112:127], v[64:67], a[68:71], v[112:127]
    v_readlane_b32 s24, v21, 9
    ds_read_b64_tr_b16 a[76:77], v17 offset:17408
    ds_read_b64_tr_b16 a[78:79], v17 offset:17920
    v_mfma_f32_32x32x16_bf16 v[144:159], v[68:71], a[68:71], v[144:159]
    s_add_u32 s25, s24, 88064
    s_waitcnt lgkmcnt(2)
    v_mfma_f32_32x32x16_bf16 v[96:111], v[72:75], a[72:75], v[96:111]
    buffer_load_dwordx4 a[16:19], v2, s[60:63], s24 offen offset:0 sc1
    ds_read_b64_tr_b16 a[64:65], v16 offset:18432
    ds_read_b64_tr_b16 a[66:67], v16 offset:18944
    v_mfma_f32_32x32x16_bf16 v[128:143], v[76:79], a[72:75], v[128:143]
    buffer_load_dwordx4 a[24:27], v2, s[60:63], s25 offen offset:0 sc1
    s_waitcnt lgkmcnt(2)
    v_mfma_f32_32x32x16_bf16 v[112:127], v[72:75], a[76:79], v[112:127]
    buffer_load_dwordx4 a[20:23], v2, s[60:63], s24 offen offset:1024 sc1
    ds_read_b64_tr_b16 a[68:69], v17 offset:18432
    ds_read_b64_tr_b16 a[70:71], v17 offset:18944
    v_mfma_f32_32x32x16_bf16 v[144:159], v[76:79], a[76:79], v[144:159]
    buffer_load_dwordx4 a[28:31], v2, s[60:63], s25 offen offset:1024 sc1
    s_waitcnt lgkmcnt(2)
    v_mfma_f32_32x32x16_bf16 v[96:111], v[80:83], a[64:67], v[96:111]
    v_readlane_b32 s22, v20, 10
    ds_read_b64_tr_b16 a[72:73], v16 offset:19456
    ds_read_b64_tr_b16 a[74:75], v16 offset:19968
    v_mfma_f32_32x32x16_bf16 v[128:143], v[84:87], a[64:67], v[128:143]
    s_add_u32 m0, s70, 49152
    s_waitcnt lgkmcnt(2)
    v_mfma_f32_32x32x16_bf16 v[112:127], v[80:83], a[68:71], v[112:127]
    buffer_load_dwordx4 v25, s[48:51], s22 offen offset:0  lds
    ds_read_b64_tr_b16 a[76:77], v17 offset:19456
    ds_read_b64_tr_b16 a[78:79], v17 offset:19968
    v_mfma_f32_32x32x16_bf16 v[144:159], v[84:87], a[68:71], v[144:159]
    buffer_load_dwordx4 v27, s[48:51], s22 offen offset:1024  lds
    s_waitcnt lgkmcnt(2)
    v_mfma_f32_32x32x16_bf16 v[96:111], v[88:91], a[72:75], v[96:111]
    buffer_load_dwordx4 v29, s[48:51], s22 offen offset:2048  lds
    v_mfma_f32_32x32x16_bf16 v[128:143], v[92:95], a[72:75], v[128:143]
    buffer_load_dwordx4 v31, s[48:51], s22 offen offset:3072  lds
    s_waitcnt lgkmcnt(0)
    v_mfma_f32_32x32x16_bf16 v[112:127], v[88:91], a[76:79], v[112:127]
    v_mfma_f32_32x32x16_bf16 v[144:159], v[92:95], a[76:79], v[144:159]
    s_waitcnt vmcnt(22)
    v_mfma_f32_32x32x16_bf16 v[96:111], v[160:163], a[48:51], v[96:111]
    ds_read_b64_tr_b16 v[168:169], v10 offset:18432
    ds_read_b64_tr_b16 v[170:171], v10 offset:19456
    v_readlane_b32 s24, v21, 10
    s_nop 0
    s_add_u32 s25, s24, 88064
    v_mfma_f32_32x32x16_bf16 v[112:127], v[160:163], a[56:59], v[112:127]
    v_mfma_f32_32x32x16_bf16 v[128:143], v[164:167], a[48:51], v[128:143]
    ds_read_b64_tr_b16 v[172:173], v11 offset:18432
    ds_read_b64_tr_b16 v[174:175], v11 offset:19456
    v_mfma_f32_32x32x16_bf16 v[144:159], v[164:167], a[56:59], v[144:159]
    buffer_load_dwordx4 a[32:35], v2, s[60:63], s24 offen offset:0 sc1
    buffer_load_dwordx4 a[40:43], v2, s[60:63], s25 offen offset:0 sc1
    s_waitcnt vmcnt(22) lgkmcnt(2)
    v_mfma_f32_32x32x16_bf16 v[96:111], v[168:171], a[52:55], v[96:111]
    s_waitcnt vmcnt(18)
    ds_read_b64_tr_b16 v[160:161], v14 offset:16384
    ds_read_b64_tr_b16 v[162:163], v14 offset:17408
    v_mfma_f32_32x32x16_bf16 v[112:127], v[168:171], a[60:63], v[112:127]
    s_waitcnt lgkmcnt(2)
    v_mfma_f32_32x32x16_bf16 v[128:143], v[172:175], a[52:55], v[128:143]
    ds_read_b64_tr_b16 v[164:165], v15 offset:16384
    ds_read_b64_tr_b16 v[166:167], v15 offset:17408
    v_mfma_f32_32x32x16_bf16 v[144:159], v[172:175], a[60:63], v[144:159]
    buffer_load_dwordx4 a[36:39], v2, s[60:63], s24 offen offset:1024 sc1
    buffer_load_dwordx4 a[44:47], v2, s[60:63], s25 offen offset:1024 sc1
    s_waitcnt vmcnt(18) lgkmcnt(2)
    v_mfma_f32_32x32x16_bf16 v[96:111], v[160:163], a[0:3], v[96:111]
    ds_read_b64_tr_b16 v[168:169], v14 offset:18432
    ds_read_b64_tr_b16 v[170:171], v14 offset:19456
    v_mfma_f32_32x32x16_bf16 v[112:127], v[160:163], a[8:11], v[112:127]
    s_waitcnt lgkmcnt(2)
    v_mfma_f32_32x32x16_bf16 v[128:143], v[164:167], a[0:3], v[128:143]
    ds_read_b64_tr_b16 v[172:173], v15 offset:18432
    ds_read_b64_tr_b16 v[174:175], v15 offset:19456
    v_mfma_f32_32x32x16_bf16 v[144:159], v[164:167], a[8:11], v[144:159]
    s_waitcnt vmcnt(16) lgkmcnt(2)
    v_mfma_f32_32x32x16_bf16 v[96:111], v[168:171], a[4:7], v[96:111]
    s_waitcnt vmcnt(12)
    ds_read_b64_tr_b16 v[160:161], v14 offset:32768
    ds_read_b64_tr_b16 v[162:163], v14 offset:33792
    v_mfma_f32_32x32x16_bf16 v[112:127], v[168:171], a[12:15], v[112:127]
    s_waitcnt lgkmcnt(2)
    v_mfma_f32_32x32x16_bf16 v[128:143], v[172:175], a[4:7], v[128:143]
    ds_read_b64_tr_b16 v[164:165], v15 offset:32768
    ds_read_b64_tr_b16 v[166:167], v15 offset:33792
    v_mfma_f32_32x32x16_bf16 v[144:159], v[172:175], a[12:15], v[144:159]
    s_waitcnt vmcnt(10) lgkmcnt(2)
    v_mfma_f32_32x32x16_bf16 v[96:111], v[160:163], a[16:19], v[96:111]
    ds_read_b64_tr_b16 v[168:169], v14 offset:34816
    ds_read_b64_tr_b16 v[170:171], v14 offset:35840
    v_mfma_f32_32x32x16_bf16 v[112:127], v[160:163], a[24:27], v[112:127]
    s_waitcnt lgkmcnt(2)
    v_mfma_f32_32x32x16_bf16 v[128:143], v[164:167], a[16:19], v[128:143]
    ds_read_b64_tr_b16 v[172:173], v15 offset:34816
    ds_read_b64_tr_b16 v[174:175], v15 offset:35840
    v_mfma_f32_32x32x16_bf16 v[144:159], v[164:167], a[24:27], v[144:159]
    s_waitcnt vmcnt(8) lgkmcnt(2)
    v_mfma_f32_32x32x16_bf16 v[96:111], v[168:171], a[20:23], v[96:111]
    s_waitcnt vmcnt(4)
    ds_read_b64_tr_b16 v[160:161], v14 offset:49152
    ds_read_b64_tr_b16 v[162:163], v14 offset:50176
    v_mfma_f32_32x32x16_bf16 v[112:127], v[168:171], a[28:31], v[112:127]
    s_waitcnt lgkmcnt(2)
    v_mfma_f32_32x32x16_bf16 v[128:143], v[172:175], a[20:23], v[128:143]
    ds_read_b64_tr_b16 v[164:165], v15 offset:49152
    ds_read_b64_tr_b16 v[166:167], v15 offset:50176
    v_mfma_f32_32x32x16_bf16 v[144:159], v[172:175], a[28:31], v[144:159]
    ds_read_b64_tr_b16 v[168:169], v14 offset:51200
    ds_read_b64_tr_b16 v[170:171], v14 offset:52224
    ds_read_b64_tr_b16 v[172:173], v15 offset:51200
    ds_read_b64_tr_b16 v[174:175], v15 offset:52224
    s_waitcnt vmcnt(0)
    s_waitcnt lgkmcnt(6)
    v_mfma_f32_32x32x16_bf16 v[96:111], v[160:163], a[32:35], v[96:111]
    s_waitcnt lgkmcnt(2)
    v_mfma_f32_32x32x16_bf16 v[96:111], v[168:171], a[36:39], v[96:111]
    v_mfma_f32_32x32x16_bf16 v[112:127], v[160:163], a[40:43], v[112:127]
    v_mfma_f32_32x32x16_bf16 v[112:127], v[168:171], a[44:47], v[112:127]
    v_mfma_f32_32x32x16_bf16 v[128:143], v[164:167], a[32:35], v[128:143]
    s_nop 8
    ds_write_b128 v18, v[96:99] offset:0
    ds_write_b128 v19, v[100:103] offset:0
    s_waitcnt lgkmcnt(2)
    v_mfma_f32_32x32x16_bf16 v[128:143], v[172:175], a[36:39], v[128:143]
    ds_write_b128 v24, v[104:107] offset:0
    ds_write_b128 v26, v[108:111] offset:0
    v_mfma_f32_32x32x16_bf16 v[144:159], v[164:167], a[40:43], v[144:159]
    ds_write_b128 v18, v[112:115] offset:32768
    ds_write_b128 v19, v[116:119] offset:32768
    v_mfma_f32_32x32x16_bf16 v[144:159], v[172:175], a[44:47], v[144:159]
    ds_write_b128 v24, v[120:123] offset:32768
    ds_write_b128 v26, v[124:127] offset:32768
    v_add_f32 v8, 1.0, v8
    v_rcp_f32 v8, v8
    s_nop 1
    ds_write_b128 v18, v[128:131] offset:128
    ds_write_b128 v19, v[132:135] offset:128
    ds_write_b128 v24, v[136:139] offset:128
    ds_write_b128 v26, v[140:143] offset:128
    s_nop 1
    ds_write_b128 v18, v[144:147] offset:32896
    ds_write_b128 v19, v[148:151] offset:32896
    ds_write_b128 v24, v[152:155] offset:32896
    s_waitcnt lgkmcnt(14)
    ds_write_b128 v26, v[156:159] offset:32896
    s_waitcnt lgkmcnt(0)
    s_barrier
    ds_read_b128 v[32:35], v5 offset:0
    ds_read_b128 v[36:39], v6 offset:0
    ds_read_b128 v[40:43], v5 offset:4096
    ds_read_b128 v[44:47], v6 offset:4096
    ds_read_b128 v[48:51], v5 offset:8192
    ds_read_b128 v[52:55], v6 offset:8192
    ds_read_b128 v[56:59], v5 offset:12288
    ds_read_b128 v[60:63], v6 offset:12288
    s_waitcnt lgkmcnt(4)
    v_pk_add_f32 v[32:33], v[32:33], v[40:41]
    v_pk_add_f32 v[34:35], v[34:35], v[42:43]
    v_pk_add_f32 v[36:37], v[36:37], v[44:45]
    v_pk_add_f32 v[38:39], v[38:39], v[46:47]
    s_waitcnt lgkmcnt(0)
    v_pk_add_f32 v[48:49], v[48:49], v[56:57]
    v_pk_add_f32 v[50:51], v[50:51], v[58:59]
    v_pk_add_f32 v[52:53], v[52:53], v[60:61]
    v_pk_add_f32 v[54:55], v[54:55], v[62:63]
    v_pk_add_f32 v[32:33], v[32:33], v[48:49]
    v_pk_add_f32 v[34:35], v[34:35], v[50:51]
    v_pk_add_f32 v[36:37], v[36:37], v[52:53]
    v_pk_add_f32 v[38:39], v[38:39], v[54:55]
    v_pk_mul_f32 v[32:33], v[32:33], v[8:9] op_sel_hi:[1,0]
    v_pk_mul_f32 v[34:35], v[34:35], v[8:9] op_sel_hi:[1,0]
    v_pk_mul_f32 v[36:37], v[36:37], v[8:9] op_sel_hi:[1,0]
    v_pk_mul_f32 v[38:39], v[38:39], v[8:9] op_sel_hi:[1,0]
    v_cvt_pk_bf16_f32 v40, v32, v33
    v_cvt_pk_bf16_f32 v41, v34, v35
    v_cvt_pk_bf16_f32 v42, v36, v37
    v_cvt_pk_bf16_f32 v43, v38, v39
    buffer_store_dwordx4 v[40:43], v4, s[56:59], s77 offen sc1
    s_endpgm
L_end:
    s_endpgm
L_rare_4:
    s_mov_b32 s14, 0
L_poll_1:
    s_mov_b64 s[18:19], vcc
    s_ff1_i32_b64 s16, vcc
    s_lshl_b64 exec, 1, s16
L_pin_3:
    s_sleep 2
    buffer_load_dword v16, v31, s[60:63], s27 offen sc1
    s_add_u32 s14, s14, 1
    s_cmp_gt_u32 s14, 200000
    s_cbranch_scc1 L_polled_2
    s_waitcnt vmcnt(0)
    v_cmp_ne_u32 vcc, s12, v16
    s_nop 0
    s_cbranch_vccnz L_pin_3
    s_mov_b64 exec, s[18:19]
    buffer_load_dword v16, v31, s[60:63], s27 offen sc1
    s_waitcnt vmcnt(0)
    v_cmp_ne_u32 vcc, s12, v16
    s_nop 0
    s_cbranch_vccnz L_poll_1
L_polled_2:
    s_mov_b64 exec, -1
    s_waitcnt vmcnt(0)
    s_branch L_back_5
L_sp_9:
    s_lshl_b32 s15, s4, 11
    s_add_u32 s15, s15, 13631488
    buffer_load_dwordx4 v[64:67], v2, s[60:63], s15 offen offset:0 sc1
    buffer_load_dwordx4 v[68:71], v2, s[60:63], s15 offen offset:1024 sc1
    ds_read_b64_tr_b16 v[136:137], v12 offset:0
    ds_read_b64_tr_b16 v[138:139], v12 offset:4096
    ds_read_b64_tr_b16 v[152:153], v30 offset:0
    ds_read_b64_tr_b16 v[154:155], v30 offset:4096
    ds_read_b64_tr_b16 v[144:145], v12 offset:8
    ds_read_b64_tr_b16 v[146:147], v12 offset:4104
    ds_read_b64_tr_b16 v[160:161], v30 offset:8
    ds_read_b64_tr_b16 v[162:163], v30 offset:4104
    ds_read_b64_tr_b16 v[140:141], v12 offset:8192
    ds_read_b64_tr_b16 v[142:143], v12 offset:12288
    ds_read_b64_tr_b16 v[156:157], v30 offset:8192
    ds_read_b64_tr_b16 v[158:159], v30 offset:12288
    ds_read_b64_tr_b16 v[148:149], v12 offset:8200
    ds_read_b64_tr_b16 v[150:151], v12 offset:12296
    ds_read_b64_tr_b16 v[164:165], v30 offset:8200
    s_waitcnt lgkmcnt(14)
    ds_read_b64_tr_b16 v[166:167], v30 offset:12296
    s_waitcnt lgkmcnt(14)
    v_mfma_f32_16x16x32_bf16 v[32:35], v[136:139], v[72:75], 0
    v_mfma_f32_16x16x32_bf16 v[40:43], v[136:139], v[80:83], 0
    s_waitcnt lgkmcnt(12)
    v_mfma_f32_16x16x32_bf16 a[0:3], v[152:155], v[72:75], 0
    v_mfma_f32_16x16x32_bf16 a[8:11], v[152:155], v[80:83], 0
    s_waitcnt lgkmcnt(10)
    v_mfma_f32_16x16x32_bf16 v[36:39], v[144:147], v[72:75], 0
    v_mfma_f32_16x16x32_bf16 v[44:47], v[144:147], v[80:83], 0
    s_waitcnt lgkmcnt(8)
    v_mfma_f32_16x16x32_bf16 a[4:7], v[160:163], v[72:75], 0
    v_mfma_f32_16x16x32_bf16 a[12:15], v[160:163], v[80:83], 0
    s_waitcnt lgkmcnt(6)
    v_mfma_f32_16x16x32_bf16 v[32:35], v[140:143], v[76:79], v[32:35]
    v_mfma_f32_16x16x32_bf16 v[40:43], v[140:143], v[84:87], v[40:43]
    s_waitcnt lgkmcnt(4)
    v_mfma_f32_16x16x32_bf16 a[0:3], v[156:159], v[76:79], a[0:3]
    v_mfma_f32_16x16x32_bf16 a[8:11], v[156:159], v[84:87], a[8:11]
    s_waitcnt lgkmcnt(2)
    v_mfma_f32_16x16x32_bf16 v[36:39], v[148:151], v[76:79], v[36:39]
    v_mfma_f32_16x16x32_bf16 v[44:47], v[148:151], v[84:87], v[44:47]
    s_waitcnt lgkmcnt(0)
    v_mfma_f32_16x16x32_bf16 a[4:7], v[164:167], v[76:79], a[4:7]
    v_mfma_f32_16x16x32_bf16 a[12:15], v[164:167], v[84:87], a[12:15]
    ds_write_b32 v13, v10 offset:32
    s_waitcnt vmcnt(8)
    v_lshlrev_b32 v56, 16, v168
    v_and_b32 v168, 0xffff0000, v168
    v_lshlrev_b32 v57, 16, v169
    v_and_b32 v169, 0xffff0000, v169
    v_lshlrev_b32 v58, 16, v170
    v_and_b32 v170, 0xffff0000, v170
    v_lshlrev_b32 v59, 16, v171
    v_and_b32 v171, 0xffff0000, v171
    v_lshlrev_b32 v60, 16, v172
    v_and_b32 v172, 0xffff0000, v172
    v_lshlrev_b32 v61, 16, v173
    v_and_b32 v173, 0xffff0000, v173
    v_lshlrev_b32 v62, 16, v174
    v_and_b32 v174, 0xffff0000, v174
    v_lshlrev_b32 v63, 16, v175
    v_and_b32 v175, 0xffff0000, v175
    v_pk_mul_f32 v[16:17], v[32:33], v[128:129]
    v_pk_mul_f32 v[32:33], v[32:33], v[120:121]
    v_pk_fma_f32 v[32:33], v[40:41], v[128:129], v[32:33]
    v_pk_fma_f32 v[40:41], v[40:41], v[120:121], v[16:17] neg_lo:[0,0,1] neg_hi:[0,0,1]
    v_pk_mul_f32 v[18:19], v[34:35], v[130:131]
    v_pk_mul_f32 v[34:35], v[34:35], v[122:123]
    v_pk_fma_f32 v[34:35], v[42:43], v[130:131], v[34:35]
    v_pk_fma_f32 v[42:43], v[42:43], v[122:123], v[18:19] neg_lo:[0,0,1] neg_hi:[0,0,1]
    v_pk_mul_f32 v[16:17], v[36:37], v[132:133]
    v_pk_mul_f32 v[36:37], v[36:37], v[124:125]
    v_pk_fma_f32 v[36:37], v[44:45], v[132:133], v[36:37]
    v_pk_fma_f32 v[44:45], v[44:45], v[124:125], v[16:17] neg_lo:[0,0,1] neg_hi:[0,0,1]
    v_pk_mul_f32 v[18:19], v[38:39], v[134:135]
    v_pk_mul_f32 v[38:39], v[38:39], v[126:127]
    v_pk_fma_f32 v[38:39], v[46:47], v[134:135], v[38:39]
    v_pk_fma_f32 v[46:47], v[46:47], v[126:127], v[18:19] neg_lo:[0,0,1] neg_hi:[0,0,1]
    v_cvt_pk_bf16_f32 v48, v32, v33
    v_cvt_pk_bf16_f32 v49, v34, v35
    v_cvt_pk_bf16_f32 v50, v36, v37
    v_cvt_pk_bf16_f32 v51, v38, v39
    v_cvt_pk_bf16_f32 v52, v40, v41
    v_cvt_pk_bf16_f32 v53, v42, v43
    v_cvt_pk_bf16_f32 v54, v44, v45
    v_cvt_pk_bf16_f32 v55, v46, v47
    v_mfma_f32_16x16x32_bf16 v[136:139], v[96:99], v[48:51], 0
    v_mfma_f32_16x16x32_bf16 v[144:147], v[104:107], v[48:51], 0
    v_mfma_f32_16x16x32_bf16 v[136:139], v[112:115], v[52:55], v[136:139]
    v_mfma_f32_16x16x32_bf16 v[144:147], v[96:99], v[52:55], v[144:147]
    v_mfma_f32_16x16x32_bf16 v[140:143], v[100:103], v[48:51], 0
    v_mfma_f32_16x16x32_bf16 v[148:151], v[108:111], v[48:51], 0
    v_mfma_f32_16x16x32_bf16 v[140:143], v[116:119], v[52:55], v[140:143]
    v_mfma_f32_16x16x32_bf16 v[148:151], v[100:103], v[52:55], v[148:151]
    v_and_b32 v31, 15, v1
    v_lshlrev_b32 v31, 6, v31
    v_lshrrev_b32 v29, 4, v1
    v_lshl_add_u32 v31, v29, 4, v31
    s_lshl_b32 s14, s4, 10
    v_add_u32 v31, s14, v31
    v_pk_mul_f32 v[16:17], v[136:137], v[168:169]
    v_pk_mul_f32 v[136:137], v[136:137], v[56:57]
    v_pk_fma_f32 v[136:137], v[144:145], v[168:169], v[136:137] neg_lo:[1,0,0] neg_hi:[1,0,0]
    v_pk_fma_f32 v[144:145], v[144:145], v[56:57], v[16:17]
    v_pk_mul_f32 v[18:19], v[138:139], v[170:171]
    v_pk_mul_f32 v[138:139], v[138:139], v[58:59]
    v_pk_fma_f32 v[138:139], v[146:147], v[170:171], v[138:139] neg_lo:[1,0,0] neg_hi:[1,0,0]
    v_pk_fma_f32 v[146:147], v[146:147], v[58:59], v[18:19]
    v_pk_mul_f32 v[16:17], v[140:141], v[172:173]
    v_pk_mul_f32 v[140:141], v[140:141], v[60:61]
    v_pk_fma_f32 v[140:141], v[148:149], v[172:173], v[140:141] neg_lo:[1,0,0] neg_hi:[1,0,0]
    v_pk_fma_f32 v[148:149], v[148:149], v[60:61], v[16:17]
    v_pk_mul_f32 v[18:19], v[142:143], v[174:175]
    v_pk_mul_f32 v[142:143], v[142:143], v[62:63]
    v_pk_fma_f32 v[142:143], v[150:151], v[174:175], v[142:143] neg_lo:[1,0,0] neg_hi:[1,0,0]
    v_pk_fma_f32 v[150:151], v[150:151], v[62:63], v[18:19]
    v_cvt_pk_bf16_f32 v48, v136, v137
    v_cvt_pk_bf16_f32 v49, v138, v139
    v_cvt_pk_bf16_f32 v50, v140, v141
    v_cvt_pk_bf16_f32 v51, v142, v143
    v_cvt_pk_bf16_f32 v52, v144, v145
    v_cvt_pk_bf16_f32 v53, v146, v147
    v_cvt_pk_bf16_f32 v54, v148, v149
    v_cvt_pk_bf16_f32 v55, v150, v151
    v_mfma_f32_16x16x32_bf16 v[32:35], v[96:99], v[48:51], 0
    v_mfma_f32_16x16x32_bf16 v[40:43], v[112:115], v[48:51], 0
    v_mfma_f32_16x16x32_bf16 v[32:35], v[104:107], v[52:55], v[32:35]
    v_mfma_f32_16x16x32_bf16 v[40:43], v[96:99], v[52:55], v[40:43]
    v_mfma_f32_16x16x32_bf16 v[36:39], v[100:103], v[48:51], 0
    v_mfma_f32_16x16x32_bf16 v[44:47], v[116:119], v[48:51], 0
    v_mfma_f32_16x16x32_bf16 v[36:39], v[108:111], v[52:55], v[36:39]
    v_mfma_f32_16x16x32_bf16 v[44:47], v[100:103], v[52:55], v[44:47]
    v_bfe_u32 v28, v1, 3, 1
    v_lshl_add_u32 v28, v28, 2, v29
    v_lshlrev_b32 v28, 16, v28
    v_and_b32 v29, 7, v1
    v_lshl_add_u32 v28, v29, 4, v28
    s_lshl_b32 s16, s4, 19
    s_lshl_b32 s15, s11, 8
    s_add_u32 s16, s16, s15
    s_add_u32 s16, s16, 4194304
    v_pk_mul_f32 v[16:17], v[32:33], v[128:129]
    v_pk_mul_f32 v[32:33], v[32:33], v[120:121]
    v_pk_fma_f32 v[32:33], v[40:41], v[128:129], v[32:33] neg_lo:[1,0,0] neg_hi:[1,0,0]
    v_pk_fma_f32 v[40:41], v[40:41], v[120:121], v[16:17]
    v_pk_mul_f32 v[18:19], v[34:35], v[130:131]
    v_pk_mul_f32 v[34:35], v[34:35], v[122:123]
    v_pk_fma_f32 v[34:35], v[42:43], v[130:131], v[34:35] neg_lo:[1,0,0] neg_hi:[1,0,0]
    v_pk_fma_f32 v[42:43], v[42:43], v[122:123], v[18:19]
    v_pk_mul_f32 v[16:17], v[36:37], v[132:133]
    v_pk_mul_f32 v[36:37], v[36:37], v[124:125]
    v_pk_fma_f32 v[36:37], v[44:45], v[132:133], v[36:37] neg_lo:[1,0,0] neg_hi:[1,0,0]
    v_pk_fma_f32 v[44:45], v[44:45], v[124:125], v[16:17]
    v_pk_mul_f32 v[18:19], v[38:39], v[134:135]
    v_pk_mul_f32 v[38:39], v[38:39], v[126:127]
    v_pk_fma_f32 v[38:39], v[46:47], v[134:135], v[38:39] neg_lo:[1,0,0] neg_hi:[1,0,0]
    v_pk_fma_f32 v[46:47], v[46:47], v[126:127], v[18:19]
    v_cvt_pk_bf16_f32 v48, v32, v33
    v_cvt_pk_bf16_f32 v49, v34, v35
    v_cvt_pk_bf16_f32 v50, v36, v37
    v_cvt_pk_bf16_f32 v51, v38, v39
    v_cvt_pk_bf16_f32 v52, v40, v41
    v_cvt_pk_bf16_f32 v53, v42, v43
    v_cvt_pk_bf16_f32 v54, v44, v45
    v_cvt_pk_bf16_f32 v55, v46, v47
    ds_write_b128 v31, v[48:51] offset:0
    ds_write_b128 v31, v[52:55] offset:4096
    v_accvgpr_read_b32 v32, a0
    v_accvgpr_read_b32 v33, a1
    v_accvgpr_read_b32 v34, a2
    v_accvgpr_read_b32 v35, a3
    v_accvgpr_read_b32 v36, a4
    v_accvgpr_read_b32 v37, a5
    v_accvgpr_read_b32 v38, a6
    v_accvgpr_read_b32 v39, a7
    v_accvgpr_read_b32 v40, a8
    v_accvgpr_read_b32 v41, a9
    v_accvgpr_read_b32 v42, a10
    v_accvgpr_read_b32 v43, a11
    v_accvgpr_read_b32 v44, a12
    v_accvgpr_read_b32 v45, a13
    v_accvgpr_read_b32 v46, a14
    v_accvgpr_read_b32 v47, a15
    s_waitcnt vmcnt(0)
    v_lshlrev_b32 v56, 16, v64
    v_and_b32 v64, 0xffff0000, v64
    v_lshlrev_b32 v57, 16, v65
    v_and_b32 v65, 0xffff0000, v65
    v_lshlrev_b32 v58, 16, v66
    v_and_b32 v66, 0xffff0000, v66
    v_lshlrev_b32 v59, 16, v67
    v_and_b32 v67, 0xffff0000, v67
    v_lshlrev_b32 v60, 16, v68
    v_and_b32 v68, 0xffff0000, v68
    v_lshlrev_b32 v61, 16, v69
    v_and_b32 v69, 0xffff0000, v69
    v_lshlrev_b32 v62, 16, v70
    v_and_b32 v70, 0xffff0000, v70
    v_lshlrev_b32 v63, 16, v71
    v_and_b32 v71, 0xffff0000, v71
    v_pk_mul_f32 v[16:17], v[32:33], v[128:129]
    v_pk_mul_f32 v[32:33], v[32:33], v[120:121]
    v_pk_fma_f32 v[32:33], v[40:41], v[128:129], v[32:33]
    v_pk_fma_f32 v[40:41], v[40:41], v[120:121], v[16:17] neg_lo:[0,0,1] neg_hi:[0,0,1]
    v_pk_mul_f32 v[18:19], v[34:35], v[130:131]
    v_pk_mul_f32 v[34:35], v[34:35], v[122:123]
    v_pk_fma_f32 v[34:35], v[42:43], v[130:131], v[34:35]
    v_pk_fma_f32 v[42:43], v[42:43], v[122:123], v[18:19] neg_lo:[0,0,1] neg_hi:[0,0,1]
    v_pk_mul_f32 v[16:17], v[36:37], v[132:133]
    v_pk_mul_f32 v[36:37], v[36:37], v[124:125]
    v_pk_fma_f32 v[36:37], v[44:45], v[132:133], v[36:37]
    v_pk_fma_f32 v[44:45], v[44:45], v[124:125], v[16:17] neg_lo:[0,0,1] neg_hi:[0,0,1]
    v_pk_mul_f32 v[18:19], v[38:39], v[134:135]
    v_pk_mul_f32 v[38:39], v[38:39], v[126:127]
    v_pk_fma_f32 v[38:39], v[46:47], v[134:135], v[38:39]
    v_pk_fma_f32 v[46:47], v[46:47], v[126:127], v[18:19] neg_lo:[0,0,1] neg_hi:[0,0,1]
    v_cvt_pk_bf16_f32 v48, v32, v33
    v_cvt_pk_bf16_f32 v49, v34, v35
    v_cvt_pk_bf16_f32 v50, v36, v37
    v_cvt_pk_bf16_f32 v51, v38, v39
    v_cvt_pk_bf16_f32 v52, v40, v41
    v_cvt_pk_bf16_f32 v53, v42, v43
    v_cvt_pk_bf16_f32 v54, v44, v45
    v_cvt_pk_bf16_f32 v55, v46, v47
    v_mfma_f32_16x16x32_bf16 v[136:139], v[96:99], v[48:51], 0
    v_mfma_f32_16x16x32_bf16 v[144:147], v[104:107], v[48:51], 0
    v_mfma_f32_16x16x32_bf16 v[136:139], v[112:115], v[52:55], v[136:139]
    v_mfma_f32_16x16x32_bf16 v[144:147], v[96:99], v[52:55], v[144:147]
    v_mfma_f32_16x16x32_bf16 v[140:143], v[100:103], v[48:51], 0
    v_mfma_f32_16x16x32_bf16 v[148:151], v[108:111], v[48:51], 0
    v_mfma_f32_16x16x32_bf16 v[140:143], v[116:119], v[52:55], v[140:143]
    v_mfma_f32_16x16x32_bf16 v[148:151], v[100:103], v[52:55], v[148:151]
    s_nop 2
    v_pk_mul_f32 v[16:17], v[136:137], v[64:65]
    v_pk_mul_f32 v[136:137], v[136:137], v[56:57]
    v_pk_fma_f32 v[136:137], v[144:145], v[64:65], v[136:137] neg_lo:[1,0,0] neg_hi:[1,0,0]
    v_pk_fma_f32 v[144:145], v[144:145], v[56:57], v[16:17]
    v_pk_mul_f32 v[18:19], v[138:139], v[66:67]
    v_pk_mul_f32 v[138:139], v[138:139], v[58:59]
    v_pk_fma_f32 v[138:139], v[146:147], v[66:67], v[138:139] neg_lo:[1,0,0] neg_hi:[1,0,0]
    v_pk_fma_f32 v[146:147], v[146:147], v[58:59], v[18:19]
    v_pk_mul_f32 v[16:17], v[140:141], v[68:69]
    v_pk_mul_f32 v[140:141], v[140:141], v[60:61]
    v_pk_fma_f32 v[140:141], v[148:149], v[68:69], v[140:141] neg_lo:[1,0,0] neg_hi:[1,0,0]
    v_pk_fma_f32 v[148:149], v[148:149], v[60:61], v[16:17]
    v_pk_mul_f32 v[18:19], v[142:143], v[70:71]
    v_pk_mul_f32 v[142:143], v[142:143], v[62:63]
    v_pk_fma_f32 v[142:143], v[150:151], v[70:71], v[142:143] neg_lo:[1,0,0] neg_hi:[1,0,0]
    v_pk_fma_f32 v[150:151], v[150:151], v[62:63], v[18:19]
    v_cvt_pk_bf16_f32 v48, v136, v137
    v_cvt_pk_bf16_f32 v49, v138, v139
    v_cvt_pk_bf16_f32 v50, v140, v141
    v_cvt_pk_bf16_f32 v51, v142, v143
    v_cvt_pk_bf16_f32 v52, v144, v145
    v_cvt_pk_bf16_f32 v53, v146, v147
    v_cvt_pk_bf16_f32 v54, v148, v149
    v_cvt_pk_bf16_f32 v55, v150, v151
    v_mfma_f32_16x16x32_bf16 v[32:35], v[96:99], v[48:51], 0
    v_mfma_f32_16x16x32_bf16 v[40:43], v[112:115], v[48:51], 0
    v_mfma_f32_16x16x32_bf16 v[32:35], v[104:107], v[52:55], v[32:35]
    v_mfma_f32_16x16x32_bf16 v[40:43], v[96:99], v[52:55], v[40:43]
    v_mfma_f32_16x16x32_bf16 v[36:39], v[100:103], v[48:51], 0
    v_mfma_f32_16x16x32_bf16 v[44:47], v[116:119], v[48:51], 0
    v_mfma_f32_16x16x32_bf16 v[36:39], v[108:111], v[52:55], v[36:39]
    v_mfma_f32_16x16x32_bf16 v[44:47], v[100:103], v[52:55], v[44:47]
    s_nop 2
    v_pk_mul_f32 v[16:17], v[32:33], v[128:129]
    v_pk_mul_f32 v[32:33], v[32:33], v[120:121]
    v_pk_fma_f32 v[32:33], v[40:41], v[128:129], v[32:33] neg_lo:[1,0,0] neg_hi:[1,0,0]
    v_pk_fma_f32 v[40:41], v[40:41], v[120:121], v[16:17]
    v_pk_mul_f32 v[18:19], v[34:35], v[130:131]
    v_pk_mul_f32 v[34:35], v[34:35], v[122:123]
    v_pk_fma_f32 v[34:35], v[42:43], v[130:131], v[34:35] neg_lo:[1,0,0] neg_hi:[1,0,0]
    v_pk_fma_f32 v[42:43], v[42:43], v[122:123], v[18:19]
    v_pk_mul_f32 v[16:17], v[36:37], v[132:133]
    v_pk_mul_f32 v[36:37], v[36:37], v[124:125]
    v_pk_fma_f32 v[36:37], v[44:45], v[132:133], v[36:37] neg_lo:[1,0,0] neg_hi:[1,0,0]
    v_pk_fma_f32 v[44:45], v[44:45], v[124:125], v[16:17]
    v_pk_mul_f32 v[18:19], v[38:39], v[134:135]
    v_pk_mul_f32 v[38:39], v[38:39], v[126:127]
    v_pk_fma_f32 v[38:39], v[46:47], v[134:135], v[38:39] neg_lo:[1,0,0] neg_hi:[1,0,0]
    v_pk_fma_f32 v[46:47], v[46:47], v[126:127], v[18:19]
    v_cvt_pk_bf16_f32 v48, v32, v33
    v_cvt_pk_bf16_f32 v49, v34, v35
    v_cvt_pk_bf16_f32 v50, v36, v37
    v_cvt_pk_bf16_f32 v51, v38, v39
    v_cvt_pk_bf16_f32 v52, v40, v41
    v_cvt_pk_bf16_f32 v53, v42, v43
    v_cvt_pk_bf16_f32 v54, v44, v45
    v_cvt_pk_bf16_f32 v55, v46, v47
    s_mov_b32 s14, 0
L_bs_11:
    ds_read_b32 v3, v14 offset:32
    s_add_u32 s14, s14, 1
    s_waitcnt lgkmcnt(0)
    v_cmp_ne_u32 vcc, 1, v3
    s_cmp_gt_u32 s14, 2000000
    s_cbranch_scc1 L_bse_12
    s_cbranch_vccnz L_bs_11
L_bse_12:
    v_add_u32 v31, 147456, v31
    v_add_u32 v30, 147456, v2
    ds_write_b128 v31, v[48:51] offset:0
    ds_write_b128 v31, v[52:55] offset:4096
    s_waitcnt lgkmcnt(0)
    ds_write_b32 v13, v10 offset:16
    s_mov_b32 s14, 0
L_bs_13:
    ds_read_b32 v3, v14 offset:16
    s_add_u32 s14, s14, 1
    s_waitcnt lgkmcnt(0)
    v_cmp_ne_u32 vcc, 1, v3
    s_cmp_gt_u32 s14, 2000000
    s_cbranch_scc1 L_bse_14
    s_cbranch_vccnz L_bs_13
L_bse_14:
    ds_read_b64_tr_b16 v[136:137], v2 offset:0
    ds_read_b64_tr_b16 v[138:139], v2 offset:1024
    ds_read_b64_tr_b16 v[152:153], v2 offset:4096
    ds_read_b64_tr_b16 v[154:155], v2 offset:5120
    ds_read_b64_tr_b16 v[144:145], v2 offset:8
    ds_read_b64_tr_b16 v[146:147], v2 offset:1032
    ds_read_b64_tr_b16 v[160:161], v2 offset:4104
    ds_read_b64_tr_b16 v[162:163], v2 offset:5128
    ds_read_b64_tr_b16 v[140:141], v2 offset:2048
    ds_read_b64_tr_b16 v[142:143], v2 offset:3072
    ds_read_b64_tr_b16 v[156:157], v2 offset:6144
    ds_read_b64_tr_b16 v[158:159], v2 offset:7168
    ds_read_b64_tr_b16 v[148:149], v2 offset:2056
    s_waitcnt lgkmcnt(14)
    ds_read_b64_tr_b16 v[150:151], v2 offset:3080
    s_waitcnt lgkmcnt(14)
    ds_read_b64_tr_b16 v[164:165], v2 offset:6152
    s_waitcnt lgkmcnt(14)
    ds_read_b64_tr_b16 v[166:167], v2 offset:7176
    s_waitcnt lgkmcnt(14)
    v_mfma_f32_16x16x32_bf16 v[32:35], v[136:139], v[72:75], 0
    s_waitcnt lgkmcnt(12)
    v_mfma_f32_16x16x32_bf16 v[32:35], v[152:155], v[80:83], v[32:35]
    s_waitcnt lgkmcnt(10)
    v_mfma_f32_16x16x32_bf16 v[36:39], v[144:147], v[72:75], 0
    s_waitcnt lgkmcnt(8)
    v_mfma_f32_16x16x32_bf16 v[36:39], v[160:163], v[80:83], v[36:39]
    s_waitcnt lgkmcnt(6)
    v_mfma_f32_16x16x32_bf16 v[32:35], v[140:143], v[76:79], v[32:35]
    s_waitcnt lgkmcnt(4)
    v_mfma_f32_16x16x32_bf16 v[32:35], v[156:159], v[84:87], v[32:35]
    s_waitcnt lgkmcnt(2)
    v_mfma_f32_16x16x32_bf16 v[36:39], v[148:151], v[76:79], v[36:39]
    s_waitcnt lgkmcnt(0)
    v_mfma_f32_16x16x32_bf16 v[36:39], v[164:167], v[84:87], v[36:39]
    ds_read_b64_tr_b16 v[136:137], v30 offset:0
    ds_read_b64_tr_b16 v[138:139], v30 offset:1024
    ds_read_b64_tr_b16 v[152:153], v30 offset:4096
    ds_read_b64_tr_b16 v[154:155], v30 offset:5120
    ds_read_b64_tr_b16 v[144:145], v30 offset:8
    ds_read_b64_tr_b16 v[146:147], v30 offset:1032
    ds_read_b64_tr_b16 v[160:161], v30 offset:4104
    ds_read_b64_tr_b16 v[162:163], v30 offset:5128
    ds_read_b64_tr_b16 v[140:141], v30 offset:2048
    ds_read_b64_tr_b16 v[142:143], v30 offset:3072
    ds_read_b64_tr_b16 v[156:157], v30 offset:6144
    ds_read_b64_tr_b16 v[158:159], v30 offset:7168
    ds_read_b64_tr_b16 v[148:149], v30 offset:2056
    ds_read_b64_tr_b16 v[150:151], v30 offset:3080
    ds_read_b64_tr_b16 v[164:165], v30 offset:6152
    s_waitcnt lgkmcnt(14)
    ds_read_b64_tr_b16 v[166:167], v30 offset:7176
    s_waitcnt lgkmcnt(14)
    v_mfma_f32_16x16x32_bf16 v[40:43], v[136:139], v[72:75], 0
    s_waitcnt lgkmcnt(12)
    v_mfma_f32_16x16x32_bf16 v[40:43], v[152:155], v[80:83], v[40:43]
    s_waitcnt lgkmcnt(10)
    v_mfma_f32_16x16x32_bf16 v[44:47], v[144:147], v[72:75], 0
    s_waitcnt lgkmcnt(8)
    v_mfma_f32_16x16x32_bf16 v[44:47], v[160:163], v[80:83], v[44:47]
    s_waitcnt lgkmcnt(6)
    v_mfma_f32_16x16x32_bf16 v[40:43], v[140:143], v[76:79], v[40:43]
    s_waitcnt lgkmcnt(4)
    v_mfma_f32_16x16x32_bf16 v[40:43], v[156:159], v[84:87], v[40:43]
    s_waitcnt lgkmcnt(2)
    v_mfma_f32_16x16x32_bf16 v[44:47], v[148:151], v[76:79], v[44:47]
    s_waitcnt lgkmcnt(0)
    v_mfma_f32_16x16x32_bf16 v[44:47], v[164:167], v[84:87], v[44:47]
    s_waitcnt vmcnt(0)
    ds_write_b32 v13, v10 offset:64
    s_waitcnt vmcnt(4)
    v_pk_mul_f32 v[32:33], v[32:33], v[20:21]
    v_pk_mul_f32 v[34:35], v[34:35], v[22:23]
    v_pk_mul_f32 v[36:37], v[36:37], v[24:25]
    v_pk_mul_f32 v[38:39], v[38:39], v[26:27]
    v_cvt_pk_bf16_f32 v48, v32, v33
    v_cvt_pk_bf16_f32 v49, v34, v35
    v_cvt_pk_bf16_f32 v50, v36, v37
    v_cvt_pk_bf16_f32 v51, v38, v39
    buffer_store_dwordx4 v[48:51], v28, s[60:63], s16 offen offset:0 sc1
    v_pk_mul_f32 v[40:41], v[40:41], v[20:21]
    v_pk_mul_f32 v[42:43], v[42:43], v[22:23]
    v_pk_mul_f32 v[44:45], v[44:45], v[24:25]
    v_pk_mul_f32 v[46:47], v[46:47], v[26:27]
    v_cvt_pk_bf16_f32 v52, v40, v41
    v_cvt_pk_bf16_f32 v53, v42, v43
    v_cvt_pk_bf16_f32 v54, v44, v45
    v_cvt_pk_bf16_f32 v55, v46, v47
    buffer_store_dwordx4 v[52:55], v28, s[60:63], s16 offen offset:128 sc1
    s_branch L_spb_10
CODE_END:
    s_endpgm
.section .rodata,"a"
.p2align 6
.amdhsa_kernel gated_mix__spectral_gfnet__dense_activation_mish__prompt_kernel
  .amdhsa_next_free_vgpr 256
  .amdhsa_next_free_sgpr 102
  .amdhsa_accum_offset 176
  .amdhsa_group_segment_fixed_size 0
  .amdhsa_kernarg_size 88
  .amdhsa_user_sgpr_count 2
  .amdhsa_user_sgpr_kernarg_segment_ptr 1
  .amdhsa_system_sgpr_workgroup_id_x 1
  .amdhsa_float_denorm_mode_32 3
.end_amdhsa_kernel
```
